```python
import torch

def _softmax(x, axis=-1):
    return torch.softmax(x, dim=axis)
def _gelu(x):
    return torch.nn.functional.gelu(x, approximate="tanh")
def _silu(x):
    return torch.nn.functional.silu(x)
def _sigmoid(x):
    return torch.sigmoid(x)
def _layernorm(x, axis=-1, eps=1e-5):
    m = x.mean(dim=axis, keepdim=True)
    v = x.var(dim=axis, keepdim=True, unbiased=False)
    return (x - m) / torch.sqrt(v + eps)
def _scatter_add(tgt, idx, src, axis=0):
    return tgt.clone().index_add_(axis, idx, src)
def _segment_sum(src, seg, n):
    out = torch.zeros((n,) + src.shape[1:], dtype=src.dtype)
    return out.index_add_(0, seg, src)
def _pad(x, pw):
    flat = tuple(v for pair in reversed(pw) for v in pair)
    return torch.nn.functional.pad(x, flat)

kernel_name = 'gated_mix__grouped_kv_mqa__grouped_kv_mqa__prompt'

def setup_inputs():

    _w = (lambda a: (lambda t: t.to(torch.bfloat16) if t.is_floating_point() else t)(torch.as_tensor(a)))
    def _A_setup():
        B, S, D, H = 1, 2048, 512, 32
        Dh = D // H
        return {
            "x": _w((lambda *s: torch.randn(*s, dtype=torch.bfloat16) * 0.05)(B, S, D)),
            "wq": _w((lambda *s: torch.randn(*s, dtype=torch.bfloat16) * 0.8)(D, H * Dh)),
            "wk": _w((lambda *s: torch.randn(*s, dtype=torch.bfloat16) * 0.8)(D, Dh)),
            "wv": _w((lambda *s: torch.randn(*s, dtype=torch.bfloat16) * 0.05)(D, Dh)),
            "wo": _w((lambda *s: torch.randn(*s, dtype=torch.bfloat16) * 0.05)(H * Dh, D)),
        }
    _A_in = _A_setup()

    def _B_setup():
        B, S, D, H = 1, 2048, 512, 32
        Dh = D // H
        return {
            "x": _w((lambda *s: torch.randn(*s, dtype=torch.bfloat16) * 0.05)(B, S, D)),
            "wq": _w((lambda *s: torch.randn(*s, dtype=torch.bfloat16) * 0.8)(D, H * Dh)),
            "wk": _w((lambda *s: torch.randn(*s, dtype=torch.bfloat16) * 0.8)(D, Dh)),
            "wv": _w((lambda *s: torch.randn(*s, dtype=torch.bfloat16) * 0.05)(D, Dh)),
            "wo": _w((lambda *s: torch.randn(*s, dtype=torch.bfloat16) * 0.05)(H * Dh, D)),
        }
    _B_in = _B_setup()

    return {
        "A_x": _A_in["x"],
        "A_wq": _A_in["wq"],
        "A_wk": _A_in["wk"],
        "A_wv": _A_in["wv"],
        "A_wo": _A_in["wo"],
        "B_x": _B_in["x"],
        "B_wq": _B_in["wq"],
        "B_wk": _B_in["wk"],
        "B_wv": _B_in["wv"],
        "B_wo": _B_in["wo"],
        "gate_w": _w((lambda *s: torch.randn(*s, dtype=torch.bfloat16) * 0.05)(512) * 16.0),
    }

def reference(A_x, A_wq, A_wk, A_wv, A_wo, B_x, B_wq, B_wk, B_wv, B_wo, gate_w):
    def _A_ref(x, wq, wk, wv, wo):
        B, S, D = x.shape
        H = 32
        Dh = D // H
        q = (lambda x, *d: x.permute(*d))((x @ wq).reshape(B, S, H, Dh), 0, 2, 1, 3)
        k = x @ wk
        v = x @ wv
        scores = torch.einsum("bhqd,bkd->bhqk", q, k) * (Dh ** -0.5)
        p = _softmax(scores, axis=-1)
        o = torch.einsum("bhqk,bkd->bhqd", p, v)
        return (lambda x, *d: x.permute(*d))(o, 0, 2, 1, 3).reshape(B, S, H * Dh) @ wo

    def _B_ref(x, wq, wk, wv, wo):
        B, S, D = x.shape
        H = 32
        Dh = D // H
        q = (lambda x, *d: x.permute(*d))((x @ wq).reshape(B, S, H, Dh), 0, 2, 1, 3)
        k = x @ wk
        v = x @ wv
        scores = torch.einsum("bhqd,bkd->bhqk", q, k) * (Dh ** -0.5)
        p = _softmax(scores, axis=-1)
        o = torch.einsum("bhqk,bkd->bhqd", p, v)
        return (lambda x, *d: x.permute(*d))(o, 0, 2, 1, 3).reshape(B, S, H * Dh) @ wo

    x = A_x
    g = _sigmoid((x * gate_w).sum(-1, keepdims=True))
    a = _A_ref(x, A_wq, A_wk, A_wv, A_wo)
    b = _B_ref(x, B_wq, B_wk, B_wv, B_wo)
    return g * a + (1 - g) * b
```

```asm
; @launch grid=(256,1,1) block=(512,1,1) lds=137984
.amdgcn_target "amdgcn-amd-amdhsa--gfx950"
.text
.globl gated_mix__grouped_kv_mqa__grouped_kv_mqa__prompt_kernel
.p2align 8
.type gated_mix__grouped_kv_mqa__grouped_kv_mqa__prompt_kernel,@function
gated_mix__grouped_kv_mqa__grouped_kv_mqa__prompt_kernel:
    s_cmp_ge_u32 s2, 256
    s_cbranch_scc1 L_end
    s_load_dwordx16 s[4:19], s[0:1], 0
    s_load_dwordx8 s[20:27], s[0:1], 64
    s_load_dwordx4 s[28:31], s[0:1], 96
    v_lshrrev_b32 v4, 6, v0
    v_and_b32 v1, 63, v0
    s_and_b32 s3, s2, 7
    v_readfirstlane_b32 s64, v4
    s_lshr_b32 s65, s2, 5
    s_lshl_b32 s69, s65, 2
    s_lshl_b32 s65, s65, 3
    s_add_u32 s65, s65, s3
    s_lshr_b32 s66, s2, 3
    s_and_b32 s66, s66, 3
    s_and_b32 s67, s66, 1
    s_lshr_b32 s68, s66, 1
    v_lshlrev_b32 v2, 4, v1
    s_lshl_b32 s85, s65, 15
    s_lshl_b32 s71, s68, 4
    s_lshl_b32 s72, s64, 1
    s_add_u32 s71, s71, s72
    s_mul_i32 s72, s71, 1040
    s_add_u32 s72, s72, 98304
    s_lshl_b32 s73, s71, 10
    s_add_u32 s73, s73, s85
    s_xor_b32 s71, s71, 16
    s_mul_i32 s74, s71, 1040
    s_add_u32 s74, s74, 98304
    s_lshl_b32 s75, s71, 10
    s_add_u32 s75, s75, s85
    v_lshrrev_b32 v4, 2, v1
    v_lshlrev_b32 v4, 10, v4
    v_and_b32 v5, 3, v1
    v_lshlrev_b32 v5, 4, v5
    v_add_u32 v106, v4, v5
    s_lshl_b32 s83, s68, 9
    s_lshl_b32 s71, s64, 6
    s_add_u32 s83, s83, s71
    s_lshl_b32 s82, s64, 13
    s_add_u32 s82, s82, 32768
    s_mov_b32 s34, 0x200000
    s_mov_b32 s35, 0x20000
    s_mov_b32 s38, 0x80000
    s_mov_b32 s39, 0x20000
    s_cmp_eq_u32 s67, 0
    s_waitcnt lgkmcnt(0)
    s_mov_b32 s32, s4
    s_mov_b32 s33, s5
    s_cselect_b32 s36, s6, s16
    s_cselect_b32 s37, s7, s17
    s_cselect_b32 s40, s8, s18
    s_cselect_b32 s41, s9, s19
    s_cselect_b32 s44, s10, s20
    s_cselect_b32 s45, s11, s21
    s_mov_b32 m0, s72
    s_add_u32 s72, s72, 1040
    buffer_load_dwordx4 v2, s[32:35], s73 offen lds
    s_add_u32 s73, s73, 1024
    s_mov_b32 m0, s72
    s_add_u32 s72, s72, 1040
    buffer_load_dwordx4 v2, s[32:35], s73 offen lds
    s_mov_b32 s42, 0x4000
    s_mov_b32 s43, 0x20000
    s_mov_b32 s46, 0x4000
    s_mov_b32 s47, 0x20000
    s_lshr_b32 s71, s2, 4
    s_add_u32 s71, s71, s64
    s_and_b32 s71, s71, 7
    s_lshl_b32 s71, s71, 11
    s_add_u32 s72, s71, 0
    s_mov_b32 m0, s72
    s_add_u32 s72, s71, 16384
    buffer_load_dwordx4 v2, s[40:43], s71 offen lds
    buffer_load_dwordx4 v2, s[40:43], s71 offen offset:1024 lds
    s_mov_b32 m0, s72
    s_nop 0
    buffer_load_dwordx4 v2, s[44:47], s71 offen lds
    buffer_load_dwordx4 v2, s[44:47], s71 offen offset:1024 lds
    s_mov_b32 m0, s74
    s_add_u32 s74, s74, 1040
    buffer_load_dwordx4 v2, s[32:35], s75 offen lds
    s_add_u32 s75, s75, 1024
    s_mov_b32 m0, s74
    s_add_u32 s74, s74, 1040
    buffer_load_dwordx4 v2, s[32:35], s75 offen lds
    s_cmp_eq_u32 s64, 2
    s_cbranch_scc0 L_nogw
    s_mov_b32 s52, s24
    s_mov_b32 s53, s25
    s_mov_b32 s54, 0x400
    s_mov_b32 s55, 0x20000
    s_mov_b32 m0, 131584
    s_nop 0
    buffer_load_dwordx4 v2, s[52:55], 0 offen lds
L_nogw:
    s_load_dword s3, s[30:31], 0x44000
    s_add_u32 s79, s69, 31
    s_and_b32 s79, s79, 31
    s_lshl_b32 s79, s79, 14
    s_add_u32 s79, s79, s83
    s_mov_b32 s78, s82
    s_mov_b32 s86, 8
L_pf:
    s_mov_b32 m0, s78
    s_add_u32 s79, s79, 16384
    s_and_b32 s79, s79, 0x7ffff
    buffer_load_dwordx4 v106, s[36:39], s79 offen lds
    s_add_u32 s78, s78, 1024
    s_sub_u32 s86, s86, 1
    s_cmp_lg_u32 s86, 0
    s_cbranch_scc1 L_pf
    s_mov_b32 s60, s30
    s_mov_b32 s61, s31
    s_mov_b32 s62, 6291456
    s_mov_b32 s63, 0x20000
    s_mov_b32 s56, s26
    s_mov_b32 s57, s27
    s_mov_b32 s58, 0x200000
    s_mov_b32 s59, 0x20000
    s_cmp_lt_u32 s2, 128
    s_cselect_b32 s48, s12, s22
    s_cselect_b32 s49, s13, s23
    s_mov_b32 s50, 0x80000
    s_mov_b32 s51, 0x20000
    s_mov_b32 s80, 0x0000ffff
    s_mov_b32 s81, 0x0000ffff
    v_mov_b32 v107, 137728
    s_cmp_eq_u32 s64, 3
    s_cbranch_scc0 L_nowo
    v_lshrrev_b32 v4, 4, v1
    v_lshlrev_b32 v4, 10, v4
    v_and_b32 v5, 15, v1
    v_lshlrev_b32 v5, 4, v5
    v_add_u32 v4, v4, v5
    s_lshr_b32 s71, s2, 2
    s_and_b32 s71, s71, 31
    s_lshl_b32 s71, s71, 14
    s_and_b32 s72, s2, 3
    s_lshl_b32 s72, s72, 8
    s_add_u32 s71, s71, s72
    s_mov_b32 m0, 132608
    s_nop 0
    buffer_load_dwordx4 v4, s[48:51], s71 offen lds
    s_add_u32 s71, s71, 4096
    s_mov_b32 m0, 133632
    s_nop 0
    buffer_load_dwordx4 v4, s[48:51], s71 offen lds
    s_add_u32 s71, s71, 4096
    s_mov_b32 m0, 134656
    s_nop 0
    buffer_load_dwordx4 v4, s[48:51], s71 offen lds
    s_add_u32 s71, s71, 4096
    s_mov_b32 m0, 135680
    s_nop 0
    buffer_load_dwordx4 v4, s[48:51], s71 offen lds
L_nowo:
    v_and_b32 v4, 31, v1
    v_lshrrev_b32 v5, 5, v1
    v_mul_u32_u24 v4, 1040, v4
    v_lshlrev_b32 v6, 4, v5
    v_add_u32 v104, v4, v6
    v_add_u32 v104, 98304, v104
    s_lshl_b32 s71, s64, 7
    s_add_u32 s71, s71, 131584
    v_add_u32 v108, s71, v6
    v_bfe_u32 v4, v1, 2, 2
    v_lshlrev_b32 v6, 3, v5
    v_add_u32 v6, v6, v4
    v_lshlrev_b32 v6, 6, v6
    v_bfe_u32 v5, v1, 4, 1
    v_lshlrev_b32 v5, 5, v5
    v_and_b32 v4, 3, v1
    v_lshlrev_b32 v4, 3, v4
    v_add3_u32 v6, v6, v4, v5
    v_add_u32 v105, s82, v6
    v_mov_b32 v48, 0
    v_mov_b32 v49, 0
    v_mov_b32 v50, 0
    v_mov_b32 v51, 0
    v_mov_b32 v52, 0
    v_mov_b32 v53, 0
    v_mov_b32 v54, 0
    v_mov_b32 v55, 0
    v_mov_b32 v56, 0
    v_mov_b32 v57, 0
    v_mov_b32 v58, 0
    v_mov_b32 v59, 0
    v_mov_b32 v60, 0
    v_mov_b32 v61, 0
    v_mov_b32 v62, 0
    v_mov_b32 v63, 0
    v_accvgpr_write_b32 a0, 0
    v_accvgpr_write_b32 a1, 0
    v_accvgpr_write_b32 a2, 0
    v_accvgpr_write_b32 a3, 0
    v_accvgpr_write_b32 a4, 0
    v_accvgpr_write_b32 a5, 0
    v_accvgpr_write_b32 a6, 0
    v_accvgpr_write_b32 a7, 0
    v_accvgpr_write_b32 a8, 0
    v_accvgpr_write_b32 a9, 0
    v_accvgpr_write_b32 a10, 0
    v_accvgpr_write_b32 a11, 0
    v_accvgpr_write_b32 a12, 0
    v_accvgpr_write_b32 a13, 0
    v_accvgpr_write_b32 a14, 0
    v_accvgpr_write_b32 a15, 0
    v_mov_b32 v16, 0
    v_mov_b32 v17, 0
    v_mov_b32 v18, 0
    v_mov_b32 v19, 0
    v_mov_b32 v20, 0
    v_mov_b32 v21, 0
    v_mov_b32 v22, 0
    v_mov_b32 v23, 0
    v_mov_b32 v24, 0
    v_mov_b32 v25, 0
    v_mov_b32 v26, 0
    v_mov_b32 v27, 0
    v_mov_b32 v28, 0
    v_mov_b32 v29, 0
    v_mov_b32 v30, 0
    v_mov_b32 v31, 0
    v_mov_b32 v32, 0
    v_mov_b32 v33, 0
    v_mov_b32 v34, 0
    v_mov_b32 v35, 0
    v_mov_b32 v36, 0
    v_mov_b32 v37, 0
    v_mov_b32 v38, 0
    v_mov_b32 v39, 0
    v_mov_b32 v40, 0
    v_mov_b32 v41, 0
    v_mov_b32 v42, 0
    v_mov_b32 v43, 0
    v_mov_b32 v44, 0
    v_mov_b32 v45, 0
    v_mov_b32 v46, 0
    v_mov_b32 v47, 0
    v_mov_b32 v72, 0
    v_mov_b32 v73, 0
    v_mov_b32 v74, 0
    v_mov_b32 v75, 0
    v_mov_b32 v76, 0
    v_mov_b32 v77, 0
    v_mov_b32 v78, 0
    v_mov_b32 v79, 0
    v_and_b32 v4, 27, v1
    v_cmp_eq_u32 vcc, 16, v4
    v_mov_b32 v5, 0x3f803f80
    s_nop 0
    v_cndmask_b32 v84, 0, v5, vcc
    v_mov_b32 v85, v84
    v_mov_b32 v86, v84
    v_mov_b32 v87, v84
    v_mov_b32 v88, v84
    v_mov_b32 v89, v84
    v_mov_b32 v90, v84
    v_mov_b32 v91, v84
    v_mov_b32 v92, v84
    v_mov_b32 v93, v84
    v_mov_b32 v94, v84
    v_mov_b32 v95, v84
    v_mov_b32 v96, v84
    v_mov_b32 v97, v84
    v_mov_b32 v98, v84
    v_mov_b32 v99, v84
    v_mov_b32 v100, 0xdddddddd
    v_mov_b32 v101, v2
    v_lshrrev_b32 v4, 5, v1
    v_lshlrev_b32 v4, 8, v4
    v_and_b32 v5, 15, v1
    v_lshlrev_b32 v5, 4, v5
    v_add_u32 v102, v4, v5
    s_nop 0
    s_cmp_lt_u32 s64, 2
    s_cselect_b32 s101, 0, 99
    s_waitcnt vmcnt(10)
    s_barrier
    s_cmp_ge_u32 s64, 2
    s_cbranch_scc1 L_bar2
    v_and_b32 v4, 15, v1
    v_lshrrev_b32 v5, 4, v1
    v_lshlrev_b32 v6, 4, v5
    s_mul_i32 s71, s68, 16640
    s_add_u32 s71, s71, 98304
    v_mul_u32_u24 v7, 1040, v4
    v_add3_u32 v112, v7, v6, s71
    v_lshlrev_b32 v5, 8, v5
    v_lshlrev_b32 v4, 3, v4
    s_and_b32 s71, s64, 1
    s_lshl_b32 s71, s71, 14
    v_add3_u32 v116, v5, v4, s71
    s_cmp_eq_u32 s64, 1
    s_cbranch_scc1 L_vproj
    ds_read_b128 a[32:35], v112 offset:0
    ds_read_b64_tr_b16 a[36:37], v116 offset:0
    ds_read_b64_tr_b16 a[38:39], v116 offset:128
    ds_read_b128 a[40:43], v112 offset:64
    ds_read_b64_tr_b16 a[44:45], v116 offset:1024
    ds_read_b64_tr_b16 a[46:47], v116 offset:1152
    ds_read_b128 a[48:51], v112 offset:128
    ds_read_b64_tr_b16 a[52:53], v116 offset:2048
    ds_read_b64_tr_b16 a[54:55], v116 offset:2176
    ds_read_b128 a[56:59], v112 offset:192
    ds_read_b64_tr_b16 a[60:61], v116 offset:3072
    ds_read_b64_tr_b16 a[62:63], v116 offset:3200
    s_waitcnt lgkmcnt(9)
    v_mfma_f32_16x16x32_bf16 v[64:67], a[36:39], a[32:35], 0
    ds_read_b128 a[32:35], v112 offset:256
    ds_read_b64_tr_b16 a[36:37], v116 offset:4096
    ds_read_b64_tr_b16 a[38:39], v116 offset:4224
    s_waitcnt lgkmcnt(9)
    v_mfma_f32_16x16x32_bf16 v[68:71], a[44:47], a[40:43], 0
    ds_read_b128 a[40:43], v112 offset:320
    ds_read_b64_tr_b16 a[44:45], v116 offset:5120
    ds_read_b64_tr_b16 a[46:47], v116 offset:5248
    s_waitcnt lgkmcnt(9)
    v_mfma_f32_16x16x32_bf16 v[64:67], a[52:55], a[48:51], v[64:67]
    ds_read_b128 a[48:51], v112 offset:384
    ds_read_b64_tr_b16 a[52:53], v116 offset:6144
    ds_read_b64_tr_b16 a[54:55], v116 offset:6272
    s_waitcnt lgkmcnt(9)
    v_mfma_f32_16x16x32_bf16 v[68:71], a[60:63], a[56:59], v[68:71]
    ds_read_b128 a[56:59], v112 offset:448
    ds_read_b64_tr_b16 a[60:61], v116 offset:7168
    ds_read_b64_tr_b16 a[62:63], v116 offset:7296
    s_waitcnt lgkmcnt(9)
    v_mfma_f32_16x16x32_bf16 v[64:67], a[36:39], a[32:35], v[64:67]
    ds_read_b128 a[32:35], v112 offset:512
    ds_read_b64_tr_b16 a[36:37], v116 offset:8192
    ds_read_b64_tr_b16 a[38:39], v116 offset:8320
    s_waitcnt lgkmcnt(9)
    v_mfma_f32_16x16x32_bf16 v[68:71], a[44:47], a[40:43], v[68:71]
    ds_read_b128 a[40:43], v112 offset:576
    ds_read_b64_tr_b16 a[44:45], v116 offset:9216
    ds_read_b64_tr_b16 a[46:47], v116 offset:9344
    s_waitcnt lgkmcnt(9)
    v_mfma_f32_16x16x32_bf16 v[64:67], a[52:55], a[48:51], v[64:67]
    ds_read_b128 a[48:51], v112 offset:640
    ds_read_b64_tr_b16 a[52:53], v116 offset:10240
    ds_read_b64_tr_b16 a[54:55], v116 offset:10368
    s_waitcnt lgkmcnt(9)
    v_mfma_f32_16x16x32_bf16 v[68:71], a[60:63], a[56:59], v[68:71]
    ds_read_b128 a[56:59], v112 offset:704
    ds_read_b64_tr_b16 a[60:61], v116 offset:11264
    ds_read_b64_tr_b16 a[62:63], v116 offset:11392
    s_waitcnt lgkmcnt(9)
    v_mfma_f32_16x16x32_bf16 v[64:67], a[36:39], a[32:35], v[64:67]
    ds_read_b128 a[32:35], v112 offset:768
    ds_read_b64_tr_b16 a[36:37], v116 offset:12288
    ds_read_b64_tr_b16 a[38:39], v116 offset:12416
    s_waitcnt lgkmcnt(9)
    v_mfma_f32_16x16x32_bf16 v[68:71], a[44:47], a[40:43], v[68:71]
    ds_read_b128 a[40:43], v112 offset:832
    ds_read_b64_tr_b16 a[44:45], v116 offset:13312
    ds_read_b64_tr_b16 a[46:47], v116 offset:13440
    s_waitcnt lgkmcnt(9)
    v_mfma_f32_16x16x32_bf16 v[64:67], a[52:55], a[48:51], v[64:67]
    ds_read_b128 a[48:51], v112 offset:896
    ds_read_b64_tr_b16 a[52:53], v116 offset:14336
    ds_read_b64_tr_b16 a[54:55], v116 offset:14464
    s_waitcnt lgkmcnt(9)
    v_mfma_f32_16x16x32_bf16 v[68:71], a[60:63], a[56:59], v[68:71]
    ds_read_b128 a[56:59], v112 offset:960
    ds_read_b64_tr_b16 a[60:61], v116 offset:15360
    ds_read_b64_tr_b16 a[62:63], v116 offset:15488
    s_waitcnt lgkmcnt(9)
    v_mfma_f32_16x16x32_bf16 v[64:67], a[36:39], a[32:35], v[64:67]
    s_waitcnt lgkmcnt(6)
    v_mfma_f32_16x16x32_bf16 v[68:71], a[44:47], a[40:43], v[68:71]
    s_waitcnt lgkmcnt(3)
    v_mfma_f32_16x16x32_bf16 v[64:67], a[52:55], a[48:51], v[64:67]
    s_waitcnt lgkmcnt(0)
    v_mfma_f32_16x16x32_bf16 v[68:71], a[60:63], a[56:59], v[68:71]
    s_mul_i32 s70, s3, 0x9E3779B1
    s_add_u32 s70, s70, 0x7F4A7C15
    v_and_b32 v6, 15, v1
    v_bfe_u32 v7, v1, 4, 1
    v_lshlrev_b32 v7, 5, v7
    v_add_u32 v6, v6, v7
    v_lshlrev_b32 v117, 4, v6
    s_lshl_b32 s71, s67, 17
    s_lshl_b32 s72, s65, 11
    s_add_u32 s71, s71, s72
    s_lshl_b32 s72, s68, 8
    s_add_u32 s71, s71, s72
    s_mov_b32 s73, 0x3eb8aa3b
    v_add_f32 v64, v64, v68
    v_add_f32 v65, v65, v69
    v_add_f32 v66, v66, v70
    v_add_f32 v67, v67, v71
    v_mul_f32 v64, s73, v64
    v_mul_f32 v65, s73, v65
    v_mul_f32 v66, s73, v66
    v_mul_f32 v67, s73, v67
    v_cvt_pk_bf16_f32 v120, v64, v65
    v_cvt_pk_bf16_f32 v121, v66, v67
    s_nop 1
    v_permlane32_swap_b32 v120, v122
    v_permlane32_swap_b32 v121, v123
    s_mov_b32 exec_hi, 0
    buffer_store_dwordx4 v[120:123], v117, s[60:63], s71 offen sc1
    s_mov_b64 exec, -1
    v_mul_f32 v4, v64, v64
    v_fmac_f32 v4, v65, v65
    v_fmac_f32 v4, v66, v66
    v_fmac_f32 v4, v67, v67
    v_mov_b32 v5, v4
    s_nop 1
    v_permlane32_swap_b32 v4, v5
    s_nop 1
    v_add_f32 v4, v4, v5
    s_nop 0
    v_mov_b32 v5, v4
    s_nop 1
    v_permlane16_swap_b32 v4, v5
    s_nop 1
    v_add_f32 v4, v4, v5
    s_nop 1
    v_max_f32_dpp v4, v4, v4 row_ror:8 row_mask:0xf bank_mask:0xf
    s_nop 1
    v_max_f32_dpp v4, v4, v4 row_ror:4 row_mask:0xf bank_mask:0xf
    s_nop 1
    v_max_f32_dpp v4, v4, v4 row_ror:2 row_mask:0xf bank_mask:0xf
    s_nop 1
    v_max_f32_dpp v4, v4, v4 row_ror:1 row_mask:0xf bank_mask:0xf
    s_lshl_b32 s71, s65, 1
    s_add_u32 s71, s71, s68
    s_lshl_b32 s71, s71, 4
    s_lshl_b32 s72, s67, 11
    s_add_u32 s71, s71, s72
    s_add_u32 s71, s71, 262144
    v_mov_b32 v125, v4
    v_mov_b32 v124, s70
    s_mov_b32 s100, s71
    s_branch L_kv_done
L_vproj:
    ds_read_b128 a[32:35], v112 offset:0
    ds_read_b64_tr_b16 a[36:37], v116 offset:0
    ds_read_b64_tr_b16 a[38:39], v116 offset:128
    ds_read_b128 a[40:43], v112 offset:64
    ds_read_b64_tr_b16 a[44:45], v116 offset:1024
    ds_read_b64_tr_b16 a[46:47], v116 offset:1152
    ds_read_b128 a[48:51], v112 offset:128
    ds_read_b64_tr_b16 a[52:53], v116 offset:2048
    ds_read_b64_tr_b16 a[54:55], v116 offset:2176
    ds_read_b128 a[56:59], v112 offset:192
    ds_read_b64_tr_b16 a[60:61], v116 offset:3072
    ds_read_b64_tr_b16 a[62:63], v116 offset:3200
    s_waitcnt lgkmcnt(9)
    v_mfma_f32_16x16x32_bf16 v[64:67], a[32:35], a[36:39], 0
    ds_read_b128 a[32:35], v112 offset:256
    ds_read_b64_tr_b16 a[36:37], v116 offset:4096
    ds_read_b64_tr_b16 a[38:39], v116 offset:4224
    s_waitcnt lgkmcnt(9)
    v_mfma_f32_16x16x32_bf16 v[68:71], a[40:43], a[44:47], 0
    ds_read_b128 a[40:43], v112 offset:320
    ds_read_b64_tr_b16 a[44:45], v116 offset:5120
    ds_read_b64_tr_b16 a[46:47], v116 offset:5248
    s_waitcnt lgkmcnt(9)
    v_mfma_f32_16x16x32_bf16 v[64:67], a[48:51], a[52:55], v[64:67]
    ds_read_b128 a[48:51], v112 offset:384
    ds_read_b64_tr_b16 a[52:53], v116 offset:6144
    ds_read_b64_tr_b16 a[54:55], v116 offset:6272
    s_waitcnt lgkmcnt(9)
    v_mfma_f32_16x16x32_bf16 v[68:71], a[56:59], a[60:63], v[68:71]
    ds_read_b128 a[56:59], v112 offset:448
    ds_read_b64_tr_b16 a[60:61], v116 offset:7168
    ds_read_b64_tr_b16 a[62:63], v116 offset:7296
    s_waitcnt lgkmcnt(9)
    v_mfma_f32_16x16x32_bf16 v[64:67], a[32:35], a[36:39], v[64:67]
    ds_read_b128 a[32:35], v112 offset:512
    ds_read_b64_tr_b16 a[36:37], v116 offset:8192
    ds_read_b64_tr_b16 a[38:39], v116 offset:8320
    s_waitcnt lgkmcnt(9)
    v_mfma_f32_16x16x32_bf16 v[68:71], a[40:43], a[44:47], v[68:71]
    ds_read_b128 a[40:43], v112 offset:576
    ds_read_b64_tr_b16 a[44:45], v116 offset:9216
    ds_read_b64_tr_b16 a[46:47], v116 offset:9344
    s_waitcnt lgkmcnt(9)
    v_mfma_f32_16x16x32_bf16 v[64:67], a[48:51], a[52:55], v[64:67]
    ds_read_b128 a[48:51], v112 offset:640
    ds_read_b64_tr_b16 a[52:53], v116 offset:10240
    ds_read_b64_tr_b16 a[54:55], v116 offset:10368
    s_waitcnt lgkmcnt(9)
    v_mfma_f32_16x16x32_bf16 v[68:71], a[56:59], a[60:63], v[68:71]
    ds_read_b128 a[56:59], v112 offset:704
    ds_read_b64_tr_b16 a[60:61], v116 offset:11264
    ds_read_b64_tr_b16 a[62:63], v116 offset:11392
    s_waitcnt lgkmcnt(9)
    v_mfma_f32_16x16x32_bf16 v[64:67], a[32:35], a[36:39], v[64:67]
    ds_read_b128 a[32:35], v112 offset:768
    ds_read_b64_tr_b16 a[36:37], v116 offset:12288
    ds_read_b64_tr_b16 a[38:39], v116 offset:12416
    s_waitcnt lgkmcnt(9)
    v_mfma_f32_16x16x32_bf16 v[68:71], a[40:43], a[44:47], v[68:71]
    ds_read_b128 a[40:43], v112 offset:832
    ds_read_b64_tr_b16 a[44:45], v116 offset:13312
    ds_read_b64_tr_b16 a[46:47], v116 offset:13440
    s_waitcnt lgkmcnt(9)
    v_mfma_f32_16x16x32_bf16 v[64:67], a[48:51], a[52:55], v[64:67]
    ds_read_b128 a[48:51], v112 offset:896
    ds_read_b64_tr_b16 a[52:53], v116 offset:14336
    ds_read_b64_tr_b16 a[54:55], v116 offset:14464
    s_waitcnt lgkmcnt(9)
    v_mfma_f32_16x16x32_bf16 v[68:71], a[56:59], a[60:63], v[68:71]
    ds_read_b128 a[56:59], v112 offset:960
    ds_read_b64_tr_b16 a[60:61], v116 offset:15360
    ds_read_b64_tr_b16 a[62:63], v116 offset:15488
    s_waitcnt lgkmcnt(9)
    v_mfma_f32_16x16x32_bf16 v[64:67], a[32:35], a[36:39], v[64:67]
    s_waitcnt lgkmcnt(6)
    v_mfma_f32_16x16x32_bf16 v[68:71], a[40:43], a[44:47], v[68:71]
    s_waitcnt lgkmcnt(3)
    v_mfma_f32_16x16x32_bf16 v[64:67], a[48:51], a[52:55], v[64:67]
    s_waitcnt lgkmcnt(0)
    v_mfma_f32_16x16x32_bf16 v[68:71], a[56:59], a[60:63], v[68:71]
    s_mul_i32 s70, s3, 0x9E3779B1
    s_add_u32 s70, s70, 0x7F4A7C15
    v_and_b32 v6, 15, v1
    v_lshrrev_b32 v7, 5, v1
    v_lshlrev_b32 v6, 4, v6
    v_lshlrev_b32 v7, 8, v7
    v_add_u32 v117, v6, v7
    s_lshl_b32 s71, s67, 17
    s_lshl_b32 s72, s65, 11
    s_add_u32 s71, s71, s72
    s_lshl_b32 s72, s68, 9
    s_add_u32 s71, s71, s72
    s_add_u32 s71, s71, 1024
    v_add_f32 v64, v64, v68
    v_add_f32 v65, v65, v69
    v_add_f32 v66, v66, v70
    v_add_f32 v67, v67, v71
    v_cvt_pk_bf16_f32 v120, v64, v65
    v_cvt_pk_bf16_f32 v121, v66, v67
    s_nop 1
    v_permlane16_swap_b32 v120, v122
    v_permlane16_swap_b32 v121, v123
    s_mov_b64 exec, s[80:81]
    buffer_store_dwordx4 v[120:123], v117, s[60:63], s71 offen sc1
    s_mov_b64 exec, -1
    v_max_f32_e64 v4, |v64|, |v65|
    v_max3_f32 v4, |v66|, |v67|, v4
    v_mov_b32 v5, v4
    s_nop 1
    v_permlane32_swap_b32 v4, v5
    s_nop 1
    v_max_f32 v4, v4, v5
    s_nop 0
    v_mov_b32 v5, v4
    s_nop 1
    v_permlane16_swap_b32 v4, v5
    s_nop 1
    v_max_f32 v4, v4, v5
    s_nop 1
    v_max_f32_dpp v4, v4, v4 row_ror:8 row_mask:0xf bank_mask:0xf
    s_nop 1
    v_max_f32_dpp v4, v4, v4 row_ror:4 row_mask:0xf bank_mask:0xf
    s_nop 1
    v_max_f32_dpp v4, v4, v4 row_ror:2 row_mask:0xf bank_mask:0xf
    s_nop 1
    v_max_f32_dpp v4, v4, v4 row_ror:1 row_mask:0xf bank_mask:0xf
    s_lshl_b32 s71, s65, 1
    s_add_u32 s71, s71, s68
    s_lshl_b32 s71, s71, 4
    s_lshl_b32 s72, s67, 11
    s_add_u32 s71, s71, s72
    s_add_u32 s71, s71, 262152
    v_mov_b32 v125, v4
    v_mov_b32 v124, s70
    s_mov_b32 s100, s71
L_kv_done:
    s_waitcnt vmcnt(9)
    s_barrier
    s_branch L_qstart
L_bar2:
    s_waitcnt vmcnt(8)
    s_barrier
L_qstart:
    s_lshl_b32 s78, s69, 5
    s_lshr_b32 s77, s69, 2
    s_mov_b32 s86, 0
    s_cmp_eq_u32 s64, 7
    s_cselect_b32 s99, 2, 99
    v_add_u32 v116, s78, v104
    s_add_u32 s78, s78, 128
    s_and_b32 s78, s78, 1023
    ds_read_b128 a[64:67], v108 offset:0
    ds_read_b128 a[68:71], v108 offset:32
    ds_read_b128 a[72:75], v108 offset:64
    ds_read_b128 a[76:79], v108 offset:96
    s_waitcnt vmcnt(6) lgkmcnt(0)
    s_mul_i32 s70, s3, 0x9E3779B1
    s_add_u32 s70, s70, 0x7F4A7C15
    ds_read_b64_tr_b16 a[32:33], v105 offset:0
    ds_read_b64_tr_b16 a[34:35], v105 offset:256
    ds_read_b128 a[36:39], v116 offset:0
    ds_read_b64_tr_b16 a[40:41], v105 offset:1024
    ds_read_b64_tr_b16 a[42:43], v105 offset:1280
    ds_read_b128 a[44:47], v116 offset:32
L_qloop:
    s_waitcnt vmcnt(5) lgkmcnt(3)
    s_cmp_eq_u32 s77, s64
    s_cselect_b64 vcc, -1, 0
    s_add_u32 s77, s77, 1
    s_and_b32 s77, s77, 7
    ds_read_b64_tr_b16 a[48:49], v105 offset:2048
    ds_read_b64_tr_b16 a[50:51], v105 offset:2304
    ds_read_b128 a[52:55], v116 offset:64
    v_mfma_f32_32x32x16_bf16 v[48:63], a[32:35], a[36:39], v[48:63]
    s_add_u32 m0, s82, 0
    s_add_u32 s79, s79, 16384
    s_and_b32 s79, s79, 0x7ffff
    buffer_load_dwordx4 v106, s[36:39], s79 offen lds
    s_cbranch_vccz L_ng1
    v_mfma_f32_32x32x16_bf16 a[96:111], a[64:67], a[36:39], 0
L_ng1:
    s_waitcnt vmcnt(5) lgkmcnt(3)
    ds_read_b64_tr_b16 a[56:57], v105 offset:3072
    ds_read_b64_tr_b16 a[58:59], v105 offset:3328
    ds_read_b128 a[60:63], v116 offset:96
    v_mfma_f32_32x32x16_bf16 a[0:15], a[40:43], a[44:47], a[0:15]
    s_add_u32 m0, s82, 1024
    s_add_u32 s79, s79, 16384
    s_and_b32 s79, s79, 0x7ffff
    buffer_load_dwordx4 v106, s[36:39], s79 offen lds
    s_cbranch_vccz L_ng2
    v_mfma_f32_32x32x16_bf16 a[96:111], a[68:71], a[44:47], a[96:111]
L_ng2:
    s_waitcnt vmcnt(5) lgkmcnt(3)
    s_cmp_eq_u32 s86, s99
    s_cbranch_scc0 L_ep3
    s_lshl_b32 s71, s67, 11
    s_add_u32 s71, s71, 262144
    buffer_load_dwordx4 a[16:19], v2, s[60:63], s71 offen sc1
    buffer_load_dwordx4 a[20:23], v2, s[60:63], s71 offen offset:1024 sc1
L_ep3:
    v_add_u32 v116, s78, v104
    s_add_u32 s78, s78, 128
    s_and_b32 s78, s78, 1023
    ds_read_b64_tr_b16 a[32:33], v105 offset:4096
    ds_read_b64_tr_b16 a[34:35], v105 offset:4352
    ds_read_b128 a[36:39], v116 offset:0
    v_mfma_f32_32x32x16_bf16 v[48:63], a[48:51], a[52:55], v[48:63]
    s_add_u32 m0, s82, 2048
    s_add_u32 s79, s79, 16384
    s_and_b32 s79, s79, 0x7ffff
    buffer_load_dwordx4 v106, s[36:39], s79 offen lds
    s_cbranch_vccz L_ng4
    v_mfma_f32_32x32x16_bf16 a[96:111], a[72:75], a[52:55], a[96:111]
L_ng4:
    s_waitcnt vmcnt(5) lgkmcnt(3)
    ds_read_b64_tr_b16 a[40:41], v105 offset:5120
    ds_read_b64_tr_b16 a[42:43], v105 offset:5376
    ds_read_b128 a[44:47], v116 offset:32
    v_mfma_f32_32x32x16_bf16 a[0:15], a[56:59], a[60:63], a[0:15]
    s_add_u32 m0, s82, 3072
    s_add_u32 s79, s79, 16384
    s_and_b32 s79, s79, 0x7ffff
    buffer_load_dwordx4 v106, s[36:39], s79 offen lds
    s_cbranch_vccz L_ng5
    v_mfma_f32_32x32x16_bf16 a[96:111], a[76:79], a[60:63], a[96:111]
L_ng5:
    s_waitcnt vmcnt(5) lgkmcnt(3)
    s_cmp_eq_u32 s86, s101
    s_cbranch_scc0 L_nf6
    s_waitcnt vmcnt(4)
    v_mov_b32 v4, 0
    s_mov_b64 exec, 1
    buffer_store_dwordx2 v[124:125], v4, s[60:63], s100 offen sc1
    s_mov_b64 exec, -1
L_nf6:
    s_cmp_eq_u32 s77, s64
    s_cselect_b64 vcc, -1, 0
    s_add_u32 s77, s77, 1
    s_and_b32 s77, s77, 7
    ds_read_b64_tr_b16 a[48:49], v105 offset:6144
    ds_read_b64_tr_b16 a[50:51], v105 offset:6400
    ds_read_b128 a[52:55], v116 offset:64
    v_mfma_f32_32x32x16_bf16 v[48:63], a[32:35], a[36:39], v[48:63]
    s_add_u32 m0, s82, 4096
    s_add_u32 s79, s79, 16384
    s_and_b32 s79, s79, 0x7ffff
    buffer_load_dwordx4 v106, s[36:39], s79 offen lds
    s_cbranch_vccz L_ng7
    v_mfma_f32_32x32x16_bf16 a[96:111], a[64:67], a[36:39], 0
L_ng7:
    s_waitcnt vmcnt(5) lgkmcnt(3)
    ds_read_b64_tr_b16 a[56:57], v105 offset:7168
    ds_read_b64_tr_b16 a[58:59], v105 offset:7424
    ds_read_b128 a[60:63], v116 offset:96
    v_mfma_f32_32x32x16_bf16 a[0:15], a[40:43], a[44:47], a[0:15]
    s_add_u32 m0, s82, 5120
    s_add_u32 s79, s79, 16384
    s_and_b32 s79, s79, 0x7ffff
    buffer_load_dwordx4 v106, s[36:39], s79 offen lds
    s_cbranch_vccz L_ng8
    v_mfma_f32_32x32x16_bf16 a[96:111], a[68:71], a[44:47], a[96:111]
L_ng8:
    s_waitcnt vmcnt(5) lgkmcnt(3)
    v_add_u32 v116, s78, v104
    s_add_u32 s78, s78, 128
    s_and_b32 s78, s78, 1023
    ds_read_b64_tr_b16 a[32:33], v105 offset:0
    ds_read_b64_tr_b16 a[34:35], v105 offset:256
    ds_read_b128 a[36:39], v116 offset:0
    v_mfma_f32_32x32x16_bf16 v[48:63], a[48:51], a[52:55], v[48:63]
    s_add_u32 m0, s82, 6144
    s_add_u32 s79, s79, 16384
    s_and_b32 s79, s79, 0x7ffff
    buffer_load_dwordx4 v106, s[36:39], s79 offen lds
    s_cbranch_vccz L_ng9
    v_mfma_f32_32x32x16_bf16 a[96:111], a[72:75], a[52:55], a[96:111]
L_ng9:
    s_waitcnt vmcnt(5) lgkmcnt(3)
    ds_read_b64_tr_b16 a[40:41], v105 offset:1024
    ds_read_b64_tr_b16 a[42:43], v105 offset:1280
    ds_read_b128 a[44:47], v116 offset:32
    v_mfma_f32_32x32x16_bf16 a[0:15], a[56:59], a[60:63], a[0:15]
    s_add_u32 m0, s82, 7168
    s_add_u32 s79, s79, 16384
    s_and_b32 s79, s79, 0x7ffff
    buffer_load_dwordx4 v106, s[36:39], s79 offen lds
    s_cbranch_vccz L_ng10
    v_mfma_f32_32x32x16_bf16 a[96:111], a[76:79], a[60:63], a[96:111]
L_ng10:
    s_add_u32 s86, s86, 1
    s_cmp_lt_u32 s86, 3
    s_cbranch_scc1 L_qloop
    s_cmp_eq_u32 s64, 7
    s_cbranch_scc0 L_qlast
    s_waitcnt vmcnt(6)
    v_accvgpr_read_b32 v118, a16
    v_accvgpr_read_b32 v119, a17
    v_accvgpr_read_b32 v120, a18
    v_accvgpr_read_b32 v121, a19
    v_accvgpr_read_b32 v122, a20
    v_accvgpr_read_b32 v123, a21
    v_accvgpr_read_b32 v124, a22
    v_accvgpr_read_b32 v125, a23
    v_cmp_ne_u32_e64 s[88:89], s70, v118
    v_cmp_ne_u32_e64 s[90:91], s70, v120
    v_cmp_ne_u32_e64 s[92:93], s70, v122
    v_cmp_ne_u32_e64 s[94:95], s70, v124
    s_nop 3
    s_or_b64 s[88:89], s[88:89], s[90:91]
    s_or_b64 s[92:93], s[92:93], s[94:95]
    s_or_b64 s[88:89], s[88:89], s[92:93]
    s_cbranch_scc0 L_qlast7
L_qlast:
    s_waitcnt vmcnt(5) lgkmcnt(3)
    s_cmp_eq_u32 s77, s64
    s_cselect_b64 vcc, -1, 0
    s_add_u32 s77, s77, 1
    s_and_b32 s77, s77, 7
    ds_read_b64_tr_b16 a[48:49], v105 offset:2048
    ds_read_b64_tr_b16 a[50:51], v105 offset:2304
    ds_read_b128 a[52:55], v116 offset:64
    v_mfma_f32_32x32x16_bf16 v[48:63], a[32:35], a[36:39], v[48:63]
    s_cbranch_vccz L_ng11
    v_mfma_f32_32x32x16_bf16 a[96:111], a[64:67], a[36:39], 0
L_ng11:
    s_waitcnt vmcnt(4) lgkmcnt(3)
    ds_read_b64_tr_b16 a[56:57], v105 offset:3072
    ds_read_b64_tr_b16 a[58:59], v105 offset:3328
    ds_read_b128 a[60:63], v116 offset:96
    v_mfma_f32_32x32x16_bf16 a[0:15], a[40:43], a[44:47], a[0:15]
    s_cbranch_vccz L_ng12
    v_mfma_f32_32x32x16_bf16 a[96:111], a[68:71], a[44:47], a[96:111]
L_ng12:
    s_waitcnt vmcnt(3) lgkmcnt(3)
    v_add_u32 v116, s78, v104
    s_add_u32 s78, s78, 128
    s_and_b32 s78, s78, 1023
    ds_read_b64_tr_b16 a[32:33], v105 offset:4096
    ds_read_b64_tr_b16 a[34:35], v105 offset:4352
    ds_read_b128 a[36:39], v116 offset:0
    v_mfma_f32_32x32x16_bf16 v[48:63], a[48:51], a[52:55], v[48:63]
    s_cbranch_vccz L_ng13
    v_mfma_f32_32x32x16_bf16 a[96:111], a[72:75], a[52:55], a[96:111]
L_ng13:
    s_waitcnt vmcnt(2) lgkmcnt(3)
    ds_read_b64_tr_b16 a[40:41], v105 offset:5120
    ds_read_b64_tr_b16 a[42:43], v105 offset:5376
    ds_read_b128 a[44:47], v116 offset:32
    v_mfma_f32_32x32x16_bf16 a[0:15], a[56:59], a[60:63], a[0:15]
    s_cbranch_vccz L_ng14
    v_mfma_f32_32x32x16_bf16 a[96:111], a[76:79], a[60:63], a[96:111]
L_ng14:
    s_waitcnt vmcnt(1) lgkmcnt(3)
    s_cmp_eq_u32 s77, s64
    s_cselect_b64 vcc, -1, 0
    s_add_u32 s77, s77, 1
    s_and_b32 s77, s77, 7
    ds_read_b64_tr_b16 a[48:49], v105 offset:6144
    ds_read_b64_tr_b16 a[50:51], v105 offset:6400
    ds_read_b128 a[52:55], v116 offset:64
    v_mfma_f32_32x32x16_bf16 v[48:63], a[32:35], a[36:39], v[48:63]
    s_cbranch_vccz L_ng15
    v_mfma_f32_32x32x16_bf16 a[96:111], a[64:67], a[36:39], 0
L_ng15:
    s_waitcnt vmcnt(0) lgkmcnt(3)
    s_cmp_eq_u32 s64, 7
    s_cbranch_scc0 L_np16
    s_lshl_b32 s71, s67, 11
    s_add_u32 s71, s71, 262144
    buffer_load_dwordx4 a[24:27], v2, s[60:63], s71 offen sc1
    buffer_load_dwordx4 a[28:31], v2, s[60:63], s71 offen offset:1024 sc1
L_np16:
    ds_read_b64_tr_b16 a[56:57], v105 offset:7168
    ds_read_b64_tr_b16 a[58:59], v105 offset:7424
    ds_read_b128 a[60:63], v116 offset:96
    v_mfma_f32_32x32x16_bf16 a[0:15], a[40:43], a[44:47], a[0:15]
    s_cbranch_vccz L_ng17
    v_mfma_f32_32x32x16_bf16 a[96:111], a[68:71], a[44:47], a[96:111]
L_ng17:
    s_waitcnt lgkmcnt(3)
    v_mfma_f32_32x32x16_bf16 v[48:63], a[48:51], a[52:55], v[48:63]
    s_cbranch_vccz L_ng18
    v_mfma_f32_32x32x16_bf16 a[96:111], a[72:75], a[52:55], a[96:111]
L_ng18:
    s_waitcnt lgkmcnt(0)
    v_mfma_f32_32x32x16_bf16 a[0:15], a[56:59], a[60:63], a[0:15]
    s_cbranch_vccz L_ng19
    v_mfma_f32_32x32x16_bf16 a[96:111], a[76:79], a[60:63], a[96:111]
L_ng19:
    s_cmp_eq_u32 s64, 7
    s_cbranch_scc0 L_pollkv_done
    s_mov_b32 s86, 262144
L_pollkv:
    s_waitcnt vmcnt(0)
    v_accvgpr_read_b32 v118, a24
    v_accvgpr_read_b32 v119, a25
    v_accvgpr_read_b32 v120, a26
    v_accvgpr_read_b32 v121, a27
    v_accvgpr_read_b32 v122, a28
    v_accvgpr_read_b32 v123, a29
    v_accvgpr_read_b32 v124, a30
    v_accvgpr_read_b32 v125, a31
    v_cmp_ne_u32_e64 s[88:89], s70, v118
    v_cmp_ne_u32_e64 s[90:91], s70, v120
    v_cmp_ne_u32_e64 s[92:93], s70, v122
    v_cmp_ne_u32_e64 s[94:95], s70, v124
    s_nop 3
    s_or_b64 s[88:89], s[88:89], s[90:91]
    s_or_b64 s[92:93], s[92:93], s[94:95]
    s_or_b64 s[88:89], s[88:89], s[92:93]
    s_cbranch_scc0 L_pollkv_ok
    s_lshl_b32 s71, s67, 11
    s_add_u32 s71, s71, 262144
    buffer_load_dwordx4 a[24:27], v2, s[60:63], s71 offen sc1
    buffer_load_dwordx4 a[28:31], v2, s[60:63], s71 offen offset:1024 sc1
    s_sub_u32 s86, s86, 1
    s_cmp_lg_u32 s86, 0
    s_cbranch_scc1 L_pollkv
    v_mov_b32 v4, 1
    v_mov_b32 v5, 60
    global_store_dword v5, v4, s[28:29]
L_pollkv_ok:
    v_mov_b32 v4, 0
    ds_write_b32 v107, v4 offset:0
    ds_write_b32 v107, v4 offset:4
    s_lshl_b32 s71, s67, 17
    s_mov_b32 s72, 0
    s_mov_b32 m0, s72
    s_add_u32 s72, s72, 4096
    buffer_load_dwordx4 v2, s[60:63], s71 offen lds
    buffer_load_dwordx4 v2, s[60:63], s71 offen offset:1024 lds
    buffer_load_dwordx4 v2, s[60:63], s71 offen offset:2048 lds
    buffer_load_dwordx4 v2, s[60:63], s71 offen offset:3072 lds
    s_add_u32 s71, s71, 4096
    s_mov_b32 m0, s72
    s_add_u32 s72, s72, 4096
    buffer_load_dwordx4 v2, s[60:63], s71 offen lds
    buffer_load_dwordx4 v2, s[60:63], s71 offen offset:1024 lds
    buffer_load_dwordx4 v2, s[60:63], s71 offen offset:2048 lds
    buffer_load_dwordx4 v2, s[60:63], s71 offen offset:3072 lds
    s_add_u32 s71, s71, 4096
    s_mov_b32 m0, s72
    s_add_u32 s72, s72, 4096
    buffer_load_dwordx4 v2, s[60:63], s71 offen lds
    buffer_load_dwordx4 v2, s[60:63], s71 offen offset:1024 lds
    buffer_load_dwordx4 v2, s[60:63], s71 offen offset:2048 lds
    buffer_load_dwordx4 v2, s[60:63], s71 offen offset:3072 lds
    s_add_u32 s71, s71, 4096
    s_mov_b32 m0, s72
    s_add_u32 s72, s72, 4096
    buffer_load_dwordx4 v2, s[60:63], s71 offen lds
    buffer_load_dwordx4 v2, s[60:63], s71 offen offset:1024 lds
    buffer_load_dwordx4 v2, s[60:63], s71 offen offset:2048 lds
    buffer_load_dwordx4 v2, s[60:63], s71 offen offset:3072 lds
    v_max_u32 v119, v119, v123
    v_max_u32 v121, v121, v125
    ds_max_u32 v107, v119 offset:0
    ds_max_u32 v107, v121 offset:4
L_pollkv_done:
    s_branch L_qdone
L_qlast7:
    v_mov_b32 v4, 0
    ds_write_b32 v107, v4 offset:0
    ds_write_b32 v107, v4 offset:4
    s_lshl_b32 s71, s67, 17
    s_mov_b32 s72, 0
    s_mov_b32 m0, s72
    s_add_u32 s72, s72, 4096
    buffer_load_dwordx4 v2, s[60:63], s71 offen lds
    buffer_load_dwordx4 v2, s[60:63], s71 offen offset:1024 lds
    buffer_load_dwordx4 v2, s[60:63], s71 offen offset:2048 lds
    buffer_load_dwordx4 v2, s[60:63], s71 offen offset:3072 lds
    s_add_u32 s71, s71, 4096
    s_mov_b32 m0, s72
    s_add_u32 s72, s72, 4096
    buffer_load_dwordx4 v2, s[60:63], s71 offen lds
    buffer_load_dwordx4 v2, s[60:63], s71 offen offset:1024 lds
    buffer_load_dwordx4 v2, s[60:63], s71 offen offset:2048 lds
    buffer_load_dwordx4 v2, s[60:63], s71 offen offset:3072 lds
    s_add_u32 s71, s71, 4096
    s_mov_b32 m0, s72
    s_add_u32 s72, s72, 4096
    buffer_load_dwordx4 v2, s[60:63], s71 offen lds
    buffer_load_dwordx4 v2, s[60:63], s71 offen offset:1024 lds
    buffer_load_dwordx4 v2, s[60:63], s71 offen offset:2048 lds
    buffer_load_dwordx4 v2, s[60:63], s71 offen offset:3072 lds
    s_add_u32 s71, s71, 4096
    s_mov_b32 m0, s72
    s_add_u32 s72, s72, 4096
    buffer_load_dwordx4 v2, s[60:63], s71 offen lds
    buffer_load_dwordx4 v2, s[60:63], s71 offen offset:1024 lds
    buffer_load_dwordx4 v2, s[60:63], s71 offen offset:2048 lds
    buffer_load_dwordx4 v2, s[60:63], s71 offen offset:3072 lds
    v_max_u32 v119, v119, v123
    v_max_u32 v121, v121, v125
    ds_max_u32 v107, v119 offset:0
    ds_max_u32 v107, v121 offset:4
    s_waitcnt vmcnt(21) lgkmcnt(3)
    s_cmp_eq_u32 s77, s64
    s_cselect_b64 vcc, -1, 0
    s_add_u32 s77, s77, 1
    s_and_b32 s77, s77, 7
    ds_read_b64_tr_b16 a[48:49], v105 offset:2048
    ds_read_b64_tr_b16 a[50:51], v105 offset:2304
    ds_read_b128 a[52:55], v116 offset:64
    v_mfma_f32_32x32x16_bf16 v[48:63], a[32:35], a[36:39], v[48:63]
    s_cbranch_vccz L_ng20
    v_mfma_f32_32x32x16_bf16 a[96:111], a[64:67], a[36:39], 0
L_ng20:
    s_waitcnt vmcnt(20) lgkmcnt(3)
    ds_read_b64_tr_b16 a[56:57], v105 offset:3072
    ds_read_b64_tr_b16 a[58:59], v105 offset:3328
    ds_read_b128 a[60:63], v116 offset:96
    v_mfma_f32_32x32x16_bf16 a[0:15], a[40:43], a[44:47], a[0:15]
    s_cbranch_vccz L_ng21
    v_mfma_f32_32x32x16_bf16 a[96:111], a[68:71], a[44:47], a[96:111]
L_ng21:
    s_waitcnt vmcnt(19) lgkmcnt(3)
    v_add_u32 v116, s78, v104
    s_add_u32 s78, s78, 128
    s_and_b32 s78, s78, 1023
    ds_read_b64_tr_b16 a[32:33], v105 offset:4096
    ds_read_b64_tr_b16 a[34:35], v105 offset:4352
    ds_read_b128 a[36:39], v116 offset:0
    v_mfma_f32_32x32x16_bf16 v[48:63], a[48:51], a[52:55], v[48:63]
    s_cbranch_vccz L_ng22
    v_mfma_f32_32x32x16_bf16 a[96:111], a[72:75], a[52:55], a[96:111]
L_ng22:
    s_waitcnt vmcnt(18) lgkmcnt(3)
    ds_read_b64_tr_b16 a[40:41], v105 offset:5120
    ds_read_b64_tr_b16 a[42:43], v105 offset:5376
    ds_read_b128 a[44:47], v116 offset:32
    v_mfma_f32_32x32x16_bf16 a[0:15], a[56:59], a[60:63], a[0:15]
    s_cbranch_vccz L_ng23
    v_mfma_f32_32x32x16_bf16 a[96:111], a[76:79], a[60:63], a[96:111]
L_ng23:
    s_waitcnt vmcnt(17) lgkmcnt(3)
    s_cmp_eq_u32 s77, s64
    s_cselect_b64 vcc, -1, 0
    s_add_u32 s77, s77, 1
    s_and_b32 s77, s77, 7
    ds_read_b64_tr_b16 a[48:49], v105 offset:6144
    ds_read_b64_tr_b16 a[50:51], v105 offset:6400
    ds_read_b128 a[52:55], v116 offset:64
    v_mfma_f32_32x32x16_bf16 v[48:63], a[32:35], a[36:39], v[48:63]
    s_cbranch_vccz L_ng24
    v_mfma_f32_32x32x16_bf16 a[96:111], a[64:67], a[36:39], 0
L_ng24:
    s_waitcnt vmcnt(16) lgkmcnt(3)
    ds_read_b64_tr_b16 a[56:57], v105 offset:7168
    ds_read_b64_tr_b16 a[58:59], v105 offset:7424
    ds_read_b128 a[60:63], v116 offset:96
    v_mfma_f32_32x32x16_bf16 a[0:15], a[40:43], a[44:47], a[0:15]
    s_cbranch_vccz L_ng25
    v_mfma_f32_32x32x16_bf16 a[96:111], a[68:71], a[44:47], a[96:111]
L_ng25:
    s_waitcnt lgkmcnt(3)
    v_mfma_f32_32x32x16_bf16 v[48:63], a[48:51], a[52:55], v[48:63]
    s_cbranch_vccz L_ng26
    v_mfma_f32_32x32x16_bf16 a[96:111], a[72:75], a[52:55], a[96:111]
L_ng26:
    s_waitcnt lgkmcnt(0)
    v_mfma_f32_32x32x16_bf16 a[0:15], a[56:59], a[60:63], a[0:15]
    s_cbranch_vccz L_ng27
    v_mfma_f32_32x32x16_bf16 a[96:111], a[76:79], a[60:63], a[96:111]
L_ng27:
L_qdone:
    v_and_b32 v4, 31, v1
    v_lshlrev_b32 v4, 5, v4
    s_lshl_b32 s71, s64, 2
    s_add_u32 s71, s71, 136704
    v_add_u32 v4, s71, v4
    s_nop 7
    v_accvgpr_read_b32 v5, a96
    ds_write_b32 v4, v5
    v_accvgpr_read_b32 v112, a0
    v_accvgpr_read_b32 v113, a1
    v_accvgpr_read_b32 v114, a2
    v_accvgpr_read_b32 v115, a3
    v_accvgpr_read_b32 v116, a4
    v_accvgpr_read_b32 v117, a5
    v_accvgpr_read_b32 v118, a6
    v_accvgpr_read_b32 v119, a7
    v_accvgpr_read_b32 v120, a8
    v_accvgpr_read_b32 v121, a9
    v_accvgpr_read_b32 v122, a10
    v_accvgpr_read_b32 v123, a11
    v_accvgpr_read_b32 v124, a12
    v_accvgpr_read_b32 v125, a13
    v_accvgpr_read_b32 v126, a14
    v_accvgpr_read_b32 v127, a15
    v_add_f32 v48, v48, v112
    v_add_f32 v49, v49, v113
    v_add_f32 v50, v50, v114
    v_add_f32 v51, v51, v115
    v_add_f32 v52, v52, v116
    v_add_f32 v53, v53, v117
    v_add_f32 v54, v54, v118
    v_add_f32 v55, v55, v119
    v_add_f32 v56, v56, v120
    v_add_f32 v57, v57, v121
    v_add_f32 v58, v58, v122
    v_add_f32 v59, v59, v123
    v_add_f32 v60, v60, v124
    v_add_f32 v61, v61, v125
    v_add_f32 v62, v62, v126
    v_add_f32 v63, v63, v127
    v_cvt_pk_bf16_f32 v8, v48, v49
    v_cvt_pk_bf16_f32 v9, v50, v51
    v_cvt_pk_bf16_f32 v10, v52, v53
    v_cvt_pk_bf16_f32 v11, v54, v55
    v_cvt_pk_bf16_f32 v12, v56, v57
    v_cvt_pk_bf16_f32 v13, v58, v59
    v_cvt_pk_bf16_f32 v14, v60, v61
    v_cvt_pk_bf16_f32 v15, v62, v63
    v_mul_f32 v110, v48, v48
    v_mul_f32 v111, v56, v56
    v_fmac_f32 v110, v49, v49
    v_fmac_f32 v111, v57, v57
    v_fmac_f32 v110, v50, v50
    v_fmac_f32 v111, v58, v58
    v_fmac_f32 v110, v51, v51
    v_fmac_f32 v111, v59, v59
    v_fmac_f32 v110, v52, v52
    v_fmac_f32 v111, v60, v60
    v_fmac_f32 v110, v53, v53
    v_fmac_f32 v111, v61, v61
    v_fmac_f32 v110, v54, v54
    v_fmac_f32 v111, v62, v62
    v_fmac_f32 v110, v55, v55
    v_fmac_f32 v111, v63, v63
    v_mov_b32 v4, v110
    v_mov_b32 v5, v111
    s_nop 1
    v_permlane32_swap_b32 v110, v4
    v_permlane32_swap_b32 v111, v5
    s_nop 1
    v_add_f32 v110, v110, v4
    v_add_f32 v111, v111, v5
    v_max_f32 v110, v110, v111
    s_cmp_eq_u32 s64, 3
    s_cbranch_scc0 L_wof_done
    v_lshrrev_b32 v4, 5, v1
    v_lshlrev_b32 v4, 2, v4
    v_bfe_u32 v5, v1, 2, 2
    v_add_u32 v4, v4, v5
    v_lshlrev_b32 v4, 8, v4
    v_bfe_u32 v5, v1, 4, 1
    v_lshlrev_b32 v5, 5, v5
    v_and_b32 v6, 3, v1
    v_lshlrev_b32 v6, 3, v6
    v_add3_u32 v4, v4, v5, v6
    v_add_u32 v4, 132608, v4
    ds_read_b64_tr_b16 v[112:113], v4 offset:0
    ds_read_b64_tr_b16 v[114:115], v4 offset:2048
    ds_read_b64_tr_b16 v[116:117], v4 offset:64
    ds_read_b64_tr_b16 v[118:119], v4 offset:2112
    ds_read_b64_tr_b16 v[120:121], v4 offset:128
    ds_read_b64_tr_b16 v[122:123], v4 offset:2176
    ds_read_b64_tr_b16 v[124:125], v4 offset:192
    ds_read_b64_tr_b16 v[126:127], v4 offset:2240
    s_lshr_b32 s71, s2, 2
    s_lshl_b32 s71, s71, 14
    s_and_b32 s72, s2, 3
    s_lshl_b32 s72, s72, 12
    s_add_u32 s71, s71, s72
    s_add_u32 s71, s71, 524288
    s_waitcnt lgkmcnt(0)
    buffer_store_dwordx4 v[112:115], v2, s[60:63], s71 offen sc1
    buffer_store_dwordx4 v[116:119], v2, s[60:63], s71 offen offset:1024 sc1
    buffer_store_dwordx4 v[120:123], v2, s[60:63], s71 offen offset:2048 sc1
    buffer_store_dwordx4 v[124:127], v2, s[60:63], s71 offen offset:3072 sc1
L_wof_done:
    s_cmp_eq_u32 s64, 7
    s_cbranch_scc0 L_bara
    s_waitcnt vmcnt(0)
L_bara:
    s_waitcnt lgkmcnt(0)
    s_barrier
    ds_read_b64 v[120:121], v107
    ds_read_b128 v[80:83], v101
    s_mov_b64 exec, s[80:81]
    ds_read_b128 v[84:87], v102 offset:1024
    ds_read_b128 v[88:91], v102 offset:1536
    s_mov_b64 exec, -1
    s_cmp_ge_u32 s64, 4
    s_cbranch_scc1 L_rest_done
    s_lshl_b32 s71, s67, 17
    s_mul_i32 s72, s64, 28672
    s_add_u32 s72, s72, 16384
    s_add_u32 s73, s71, s72
    s_mov_b32 s86, 7
L_rest:
    s_mov_b32 m0, s72
    s_add_u32 s72, s72, 4096
    buffer_load_dwordx4 v2, s[60:63], s73 offen lds
    buffer_load_dwordx4 v2, s[60:63], s73 offen offset:1024 lds
    buffer_load_dwordx4 v2, s[60:63], s73 offen offset:2048 lds
    buffer_load_dwordx4 v2, s[60:63], s73 offen offset:3072 lds
    s_add_u32 s73, s73, 4096
    s_sub_u32 s86, s86, 1
    s_cmp_lg_u32 s86, 0
    s_cbranch_scc1 L_rest
L_rest_done:
    s_waitcnt lgkmcnt(0)
    v_mfma_f32_32x32x16_bf16 v[48:63], v[80:83], v[8:11], 0
    v_mul_f32 v4, v110, v120
    s_mov_b32 s71, 0x44c80000
    v_cmp_nle_f32_e64 s[88:89], v4, s71
    s_mov_b32 s72, 0x53800000
    v_cmp_nle_f32_e64 s[90:91], v121, s72
    s_mov_b32 s72, 0x2b800000
    v_cmp_nge_f32_e64 s[92:93], v121, s72
    s_nop 3
    s_or_b64 s[88:89], s[88:89], s[90:91]
    s_or_b64 s[88:89], s[88:89], s[92:93]
    s_cmp_ge_u32 s64, 4
    s_cbranch_scc1 L_prio_g2
    s_setprio 0
    s_mov_b32 s98, 99
    s_branch L_prio_done
L_prio_g2:
    s_setprio 1
    s_mov_b32 s98, 6
L_prio_done:
    s_cmp_lg_u64 s[88:89], 0
    s_cbranch_scc1 L_slow
    s_mov_b32 s84, 0
.p2align 6
L_main:
    s_cmp_eq_u32 s84, 1
    s_cbranch_scc1 L_blk_1
    s_cmp_eq_u32 s84, 2
    s_cbranch_scc1 L_blk_2
L_main_go:
    v_exp_f32 v48, v48
    v_exp_f32 v49, v49
    v_smfmac_f32_32x32x32_bf16 v[32:47], v[96:99], v[72:79], v100
    s_mov_b64 exec, s[80:81]
    ds_read_b128 v[92:95], v102 offset:3072
    ds_read_b128 v[96:99], v102 offset:3584
    s_mov_b64 exec, -1
    v_exp_f32 v50, v50
    v_exp_f32 v51, v51
    v_exp_f32 v52, v52
    v_mfma_f32_32x32x16_bf16 v[64:79], v[80:83], v[12:15], 0
    ds_read_b128 v[80:83], v101 offset:2048
    v_exp_f32 v53, v53
    v_exp_f32 v54, v54
    v_exp_f32 v55, v55
    v_exp_f32 v56, v56
    v_exp_f32 v57, v57
    v_exp_f32 v58, v58
    v_smfmac_f32_32x32x32_bf16 v[16:31], v[84:87], v[48:55], v100
    v_exp_f32 v59, v59
    v_exp_f32 v60, v60
    v_exp_f32 v61, v61
    v_exp_f32 v62, v62
    v_exp_f32 v63, v63
    v_exp_f32 v64, v64
    v_exp_f32 v65, v65
    v_smfmac_f32_32x32x32_bf16 v[16:31], v[88:91], v[56:63], v100
    s_waitcnt lgkmcnt(0)
    v_exp_f32 v66, v66
    v_exp_f32 v67, v67
    v_exp_f32 v68, v68
    v_mfma_f32_32x32x16_bf16 v[48:63], v[80:83], v[8:11], 0
    v_exp_f32 v69, v69
    v_exp_f32 v70, v70
    v_exp_f32 v71, v71
    v_exp_f32 v72, v72
    v_exp_f32 v73, v73
    v_exp_f32 v74, v74
    v_smfmac_f32_32x32x32_bf16 v[32:47], v[84:87], v[64:71], v100
    v_exp_f32 v75, v75
    v_exp_f32 v76, v76
    v_exp_f32 v77, v77
    v_exp_f32 v78, v78
    v_exp_f32 v79, v79
    v_exp_f32 v48, v48
    v_exp_f32 v49, v49
    v_smfmac_f32_32x32x32_bf16 v[32:47], v[88:91], v[72:79], v100
    s_mov_b64 exec, s[80:81]
    ds_read_b128 v[84:87], v102 offset:5120
    ds_read_b128 v[88:91], v102 offset:5632
    s_mov_b64 exec, -1
    v_exp_f32 v50, v50
    v_exp_f32 v51, v51
    v_exp_f32 v52, v52
    v_mfma_f32_32x32x16_bf16 v[64:79], v[80:83], v[12:15], 0
    ds_read_b128 v[80:83], v101 offset:4096
    v_exp_f32 v53, v53
    v_exp_f32 v54, v54
    v_exp_f32 v55, v55
    v_exp_f32 v56, v56
    v_exp_f32 v57, v57
    v_exp_f32 v58, v58
    v_smfmac_f32_32x32x32_bf16 v[16:31], v[92:95], v[48:55], v100
    v_exp_f32 v59, v59
    v_exp_f32 v60, v60
    v_exp_f32 v61, v61
    v_exp_f32 v62, v62
    v_exp_f32 v63, v63
    v_exp_f32 v64, v64
    v_exp_f32 v65, v65
    v_smfmac_f32_32x32x32_bf16 v[16:31], v[96:99], v[56:63], v100
    s_waitcnt lgkmcnt(0)
    v_exp_f32 v66, v66
    v_exp_f32 v67, v67
    v_exp_f32 v68, v68
    v_mfma_f32_32x32x16_bf16 v[48:63], v[80:83], v[8:11], 0
    v_exp_f32 v69, v69
    v_exp_f32 v70, v70
    v_exp_f32 v71, v71
    v_exp_f32 v72, v72
    v_exp_f32 v73, v73
    v_exp_f32 v74, v74
    v_smfmac_f32_32x32x32_bf16 v[32:47], v[92:95], v[64:71], v100
    v_exp_f32 v75, v75
    v_exp_f32 v76, v76
    v_exp_f32 v77, v77
    v_exp_f32 v78, v78
    v_exp_f32 v79, v79
    v_exp_f32 v48, v48
    v_exp_f32 v49, v49
    v_smfmac_f32_32x32x32_bf16 v[32:47], v[96:99], v[72:79], v100
    s_mov_b64 exec, s[80:81]
    ds_read_b128 v[92:95], v102 offset:7168
    ds_read_b128 v[96:99], v102 offset:7680
    s_mov_b64 exec, -1
    v_exp_f32 v50, v50
    v_exp_f32 v51, v51
    v_exp_f32 v52, v52
    v_mfma_f32_32x32x16_bf16 v[64:79], v[80:83], v[12:15], 0
    ds_read_b128 v[80:83], v101 offset:6144
    v_exp_f32 v53, v53
    v_exp_f32 v54, v54
    v_exp_f32 v55, v55
    v_exp_f32 v56, v56
    v_exp_f32 v57, v57
    v_exp_f32 v58, v58
    v_smfmac_f32_32x32x32_bf16 v[16:31], v[84:87], v[48:55], v100
    v_exp_f32 v59, v59
    v_exp_f32 v60, v60
    v_exp_f32 v61, v61
    v_exp_f32 v62, v62
    v_exp_f32 v63, v63
    v_exp_f32 v64, v64
    v_exp_f32 v65, v65
    v_smfmac_f32_32x32x32_bf16 v[16:31], v[88:91], v[56:63], v100
    s_waitcnt lgkmcnt(0)
    v_exp_f32 v66, v66
    v_exp_f32 v67, v67
    v_exp_f32 v68, v68
    v_mfma_f32_32x32x16_bf16 v[48:63], v[80:83], v[8:11], 0
    v_exp_f32 v69, v69
    v_exp_f32 v70, v70
    v_exp_f32 v71, v71
    v_exp_f32 v72, v72
    v_exp_f32 v73, v73
    v_exp_f32 v74, v74
    v_smfmac_f32_32x32x32_bf16 v[32:47], v[84:87], v[64:71], v100
    v_exp_f32 v75, v75
    v_exp_f32 v76, v76
    v_exp_f32 v77, v77
    v_exp_f32 v78, v78
    v_exp_f32 v79, v79
    v_exp_f32 v48, v48
    v_exp_f32 v49, v49
    v_smfmac_f32_32x32x32_bf16 v[32:47], v[88:91], v[72:79], v100
    s_mov_b64 exec, s[80:81]
    ds_read_b128 v[84:87], v102 offset:9216
    ds_read_b128 v[88:91], v102 offset:9728
    s_mov_b64 exec, -1
    v_exp_f32 v50, v50
    v_exp_f32 v51, v51
    v_exp_f32 v52, v52
    v_mfma_f32_32x32x16_bf16 v[64:79], v[80:83], v[12:15], 0
    ds_read_b128 v[80:83], v101 offset:8192
    v_exp_f32 v53, v53
    v_exp_f32 v54, v54
    v_exp_f32 v55, v55
    v_exp_f32 v56, v56
    v_exp_f32 v57, v57
    v_exp_f32 v58, v58
    v_smfmac_f32_32x32x32_bf16 v[16:31], v[92:95], v[48:55], v100
    v_exp_f32 v59, v59
    v_exp_f32 v60, v60
    v_exp_f32 v61, v61
    v_exp_f32 v62, v62
    v_exp_f32 v63, v63
    v_exp_f32 v64, v64
    v_exp_f32 v65, v65
    v_smfmac_f32_32x32x32_bf16 v[16:31], v[96:99], v[56:63], v100
    s_waitcnt lgkmcnt(0)
    v_exp_f32 v66, v66
    v_exp_f32 v67, v67
    v_exp_f32 v68, v68
    v_mfma_f32_32x32x16_bf16 v[48:63], v[80:83], v[8:11], 0
    v_exp_f32 v69, v69
    v_exp_f32 v70, v70
    v_exp_f32 v71, v71
    v_exp_f32 v72, v72
    v_exp_f32 v73, v73
    v_exp_f32 v74, v74
    v_smfmac_f32_32x32x32_bf16 v[32:47], v[92:95], v[64:71], v100
    v_exp_f32 v75, v75
    v_exp_f32 v76, v76
    v_exp_f32 v77, v77
    v_exp_f32 v78, v78
    v_exp_f32 v79, v79
    v_exp_f32 v48, v48
    v_exp_f32 v49, v49
    v_smfmac_f32_32x32x32_bf16 v[32:47], v[96:99], v[72:79], v100
    s_mov_b64 exec, s[80:81]
    ds_read_b128 v[92:95], v102 offset:11264
    ds_read_b128 v[96:99], v102 offset:11776
    s_mov_b64 exec, -1
    v_exp_f32 v50, v50
    v_exp_f32 v51, v51
    v_exp_f32 v52, v52
    v_mfma_f32_32x32x16_bf16 v[64:79], v[80:83], v[12:15], 0
    ds_read_b128 v[80:83], v101 offset:10240
    v_exp_f32 v53, v53
    v_exp_f32 v54, v54
    v_exp_f32 v55, v55
    v_exp_f32 v56, v56
    v_exp_f32 v57, v57
    v_exp_f32 v58, v58
    v_smfmac_f32_32x32x32_bf16 v[16:31], v[84:87], v[48:55], v100
    v_exp_f32 v59, v59
    v_exp_f32 v60, v60
    v_exp_f32 v61, v61
    v_exp_f32 v62, v62
    v_exp_f32 v63, v63
    v_exp_f32 v64, v64
    v_exp_f32 v65, v65
    v_smfmac_f32_32x32x32_bf16 v[16:31], v[88:91], v[56:63], v100
    s_waitcnt lgkmcnt(0)
    v_exp_f32 v66, v66
    v_exp_f32 v67, v67
    v_exp_f32 v68, v68
    v_mfma_f32_32x32x16_bf16 v[48:63], v[80:83], v[8:11], 0
    v_exp_f32 v69, v69
    v_exp_f32 v70, v70
    v_exp_f32 v71, v71
    v_exp_f32 v72, v72
    v_exp_f32 v73, v73
    v_exp_f32 v74, v74
    v_smfmac_f32_32x32x32_bf16 v[32:47], v[84:87], v[64:71], v100
    v_exp_f32 v75, v75
    v_exp_f32 v76, v76
    v_exp_f32 v77, v77
    v_exp_f32 v78, v78
    v_exp_f32 v79, v79
    s_cmp_eq_u32 s84, s98
    s_cbranch_scc1 L_blk_prio
L_main_tp:
    v_exp_f32 v48, v48
    v_exp_f32 v49, v49
    v_smfmac_f32_32x32x32_bf16 v[32:47], v[88:91], v[72:79], v100
    s_mov_b64 exec, s[80:81]
    ds_read_b128 v[84:87], v102 offset:13312
    ds_read_b128 v[88:91], v102 offset:13824
    s_mov_b64 exec, -1
    v_exp_f32 v50, v50
    v_exp_f32 v51, v51
    v_exp_f32 v52, v52
    v_mfma_f32_32x32x16_bf16 v[64:79], v[80:83], v[12:15], 0
    ds_read_b128 v[80:83], v101 offset:12288
    v_exp_f32 v53, v53
    v_exp_f32 v54, v54
    v_exp_f32 v55, v55
    v_exp_f32 v56, v56
    v_exp_f32 v57, v57
    v_exp_f32 v58, v58
    v_smfmac_f32_32x32x32_bf16 v[16:31], v[92:95], v[48:55], v100
    v_exp_f32 v59, v59
    v_exp_f32 v60, v60
    v_exp_f32 v61, v61
    v_exp_f32 v62, v62
    v_exp_f32 v63, v63
    v_exp_f32 v64, v64
    v_exp_f32 v65, v65
    v_smfmac_f32_32x32x32_bf16 v[16:31], v[96:99], v[56:63], v100
    s_waitcnt lgkmcnt(0)
    v_exp_f32 v66, v66
    v_exp_f32 v67, v67
    v_exp_f32 v68, v68
    v_mfma_f32_32x32x16_bf16 v[48:63], v[80:83], v[8:11], 0
    v_exp_f32 v69, v69
    v_exp_f32 v70, v70
    v_exp_f32 v71, v71
    v_exp_f32 v72, v72
    v_exp_f32 v73, v73
    v_exp_f32 v74, v74
    v_smfmac_f32_32x32x32_bf16 v[32:47], v[92:95], v[64:71], v100
    v_exp_f32 v75, v75
    v_exp_f32 v76, v76
    v_exp_f32 v77, v77
    v_exp_f32 v78, v78
    v_exp_f32 v79, v79
    s_cmp_eq_u32 s84, 0
    s_cbranch_scc1 L_blk_bar
L_main_t6:
    v_exp_f32 v48, v48
    v_exp_f32 v49, v49
    v_smfmac_f32_32x32x32_bf16 v[32:47], v[96:99], v[72:79], v100
    s_mov_b64 exec, s[80:81]
    ds_read_b128 v[92:95], v102 offset:15360
    ds_read_b128 v[96:99], v102 offset:15872
    s_mov_b64 exec, -1
    v_exp_f32 v50, v50
    v_exp_f32 v51, v51
    v_exp_f32 v52, v52
    v_mfma_f32_32x32x16_bf16 v[64:79], v[80:83], v[12:15], 0
    ds_read_b128 v[80:83], v101 offset:14336
    v_exp_f32 v53, v53
    v_exp_f32 v54, v54
    v_exp_f32 v55, v55
    v_exp_f32 v56, v56
    v_exp_f32 v57, v57
    v_exp_f32 v58, v58
    v_smfmac_f32_32x32x32_bf16 v[16:31], v[84:87], v[48:55], v100
    v_exp_f32 v59, v59
    v_exp_f32 v60, v60
    v_exp_f32 v61, v61
    v_exp_f32 v62, v62
    v_exp_f32 v63, v63
    v_exp_f32 v64, v64
    v_exp_f32 v65, v65
    v_smfmac_f32_32x32x32_bf16 v[16:31], v[88:91], v[56:63], v100
    s_waitcnt lgkmcnt(0)
    v_exp_f32 v66, v66
    v_exp_f32 v67, v67
    v_exp_f32 v68, v68
    v_mfma_f32_32x32x16_bf16 v[48:63], v[80:83], v[8:11], 0
    v_exp_f32 v69, v69
    v_exp_f32 v70, v70
    v_exp_f32 v71, v71
    v_exp_f32 v72, v72
    v_exp_f32 v73, v73
    v_exp_f32 v74, v74
    v_smfmac_f32_32x32x32_bf16 v[32:47], v[84:87], v[64:71], v100
    v_exp_f32 v75, v75
    v_exp_f32 v76, v76
    v_exp_f32 v77, v77
    v_exp_f32 v78, v78
    v_exp_f32 v79, v79
    v_exp_f32 v48, v48
    v_exp_f32 v49, v49
    v_smfmac_f32_32x32x32_bf16 v[32:47], v[88:91], v[72:79], v100
    s_mov_b64 exec, s[80:81]
    ds_read_b128 v[84:87], v102 offset:17408
    ds_read_b128 v[88:91], v102 offset:17920
    s_mov_b64 exec, -1
    v_exp_f32 v50, v50
    v_exp_f32 v51, v51
    v_exp_f32 v52, v52
    v_mfma_f32_32x32x16_bf16 v[64:79], v[80:83], v[12:15], 0
    ds_read_b128 v[80:83], v101 offset:16384
    v_exp_f32 v53, v53
    v_exp_f32 v54, v54
    v_exp_f32 v55, v55
    v_exp_f32 v56, v56
    v_exp_f32 v57, v57
    v_exp_f32 v58, v58
    v_smfmac_f32_32x32x32_bf16 v[16:31], v[92:95], v[48:55], v100
    v_exp_f32 v59, v59
    v_exp_f32 v60, v60
    v_exp_f32 v61, v61
    v_exp_f32 v62, v62
    v_exp_f32 v63, v63
    v_exp_f32 v64, v64
    v_exp_f32 v65, v65
    v_smfmac_f32_32x32x32_bf16 v[16:31], v[96:99], v[56:63], v100
    s_waitcnt lgkmcnt(0)
    v_exp_f32 v66, v66
    v_exp_f32 v67, v67
    v_exp_f32 v68, v68
    v_mfma_f32_32x32x16_bf16 v[48:63], v[80:83], v[8:11], 0
    v_exp_f32 v69, v69
    v_exp_f32 v70, v70
    v_exp_f32 v71, v71
    v_exp_f32 v72, v72
    v_exp_f32 v73, v73
    v_exp_f32 v74, v74
    v_smfmac_f32_32x32x32_bf16 v[32:47], v[92:95], v[64:71], v100
    v_exp_f32 v75, v75
    v_exp_f32 v76, v76
    v_exp_f32 v77, v77
    v_exp_f32 v78, v78
    v_exp_f32 v79, v79
    v_add_u32 v101, 0x4000, v101
    v_add_u32 v102, 0x4000, v102
    s_add_u32 s84, s84, 1
    s_cmp_lt_u32 s84, 8
    s_cbranch_scc1 L_main
    s_nop 1
    v_smfmac_f32_32x32x32_bf16 v[32:47], v[96:99], v[72:79], v100
L_epi:
    s_nop 15
    v_rcp_f32 v4, v24
    s_nop 0
    v_mul_f32 v4, v4, v3
    v_mul_f32 v16, v4, v16
    v_mul_f32 v17, v4, v17
    v_mul_f32 v18, v4, v18
    v_mul_f32 v19, v4, v19
    v_mul_f32 v20, v4, v20
    v_mul_f32 v21, v4, v21
    v_mul_f32 v22, v4, v22
    v_mul_f32 v23, v4, v23
    v_cvt_pk_bf16_f32 v112, v16, v17
    v_cvt_pk_bf16_f32 v113, v18, v19
    v_cvt_pk_bf16_f32 v114, v20, v21
    v_cvt_pk_bf16_f32 v115, v22, v23
    v_rcp_f32 v4, v40
    s_nop 0
    v_mul_f32 v4, v4, v3
    v_mul_f32 v32, v4, v32
    v_mul_f32 v33, v4, v33
    v_mul_f32 v34, v4, v34
    v_mul_f32 v35, v4, v35
    v_mul_f32 v36, v4, v36
    v_mul_f32 v37, v4, v37
    v_mul_f32 v38, v4, v38
    v_mul_f32 v39, v4, v39
    v_cvt_pk_bf16_f32 v116, v32, v33
    v_cvt_pk_bf16_f32 v117, v34, v35
    v_cvt_pk_bf16_f32 v118, v36, v37
    v_cvt_pk_bf16_f32 v119, v38, v39
    s_lshl_b32 s72, s67, 15
    s_lshl_b32 s73, s68, 14
    s_add_u32 s72, s72, s73
    s_lshl_b32 s73, s64, 11
    s_add_u32 s72, s72, s73
    s_lshl_b32 s71, s65, 16
    s_add_u32 s71, s71, s72
    s_add_u32 s71, s71, 2097152
    buffer_store_dwordx4 v[112:115], v2, s[60:63], s71 offen sc1
    buffer_store_dwordx4 v[116:119], v2, s[60:63], s71 offen offset:1024 sc1
    v_add_u32 v4, s72, v2
    s_lshl_b32 s75, s65, 7
    s_add_u32 s75, s75, 294912
    s_lshl_b32 s72, s66, 3
    s_add_u32 s72, s72, s64
    s_lshl_b32 s72, s72, 2
    s_add_u32 s72, s72, s75
    v_mov_b32 v6, s70
    v_mov_b32 v5, 0
    s_waitcnt vmcnt(0)
    s_mov_b64 exec, 1
    buffer_store_dword v6, v5, s[60:63], s72 offen sc1
    s_mov_b64 exec, -1
    s_barrier
    ds_write_b128 v4, v[112:115]
    ds_write_b128 v4, v[116:119] offset:1024
    s_waitcnt lgkmcnt(0)
    s_barrier
    s_xor_b32 s73, s66, 0
    s_and_b32 s74, s73, 1
    s_lshl_b32 s74, s74, 15
    s_lshr_b32 s73, s73, 1
    s_lshl_b32 s73, s73, 14
    s_add_u32 s73, s73, s74
    s_lshr_b32 s74, s64, 2
    s_lshl_b32 s74, s74, 13
    s_add_u32 s73, s73, s74
    v_add_u32 v80, s73, v2
    s_xor_b32 s73, s66, 1
    s_and_b32 s74, s73, 1
    s_lshl_b32 s74, s74, 15
    s_lshr_b32 s73, s73, 1
    s_lshl_b32 s73, s73, 14
    s_add_u32 s73, s73, s74
    s_lshr_b32 s74, s64, 2
    s_lshl_b32 s74, s74, 13
    s_add_u32 s73, s73, s74
    v_add_u32 v81, s73, v2
    s_xor_b32 s73, s66, 2
    s_and_b32 s74, s73, 1
    s_lshl_b32 s74, s74, 15
    s_lshr_b32 s73, s73, 1
    s_lshl_b32 s73, s73, 14
    s_add_u32 s73, s73, s74
    s_lshr_b32 s74, s64, 2
    s_lshl_b32 s74, s74, 13
    s_add_u32 s73, s73, s74
    v_add_u32 v82, s73, v2
    s_xor_b32 s73, s66, 3
    s_and_b32 s74, s73, 1
    s_lshl_b32 s74, s74, 15
    s_lshr_b32 s73, s73, 1
    s_lshl_b32 s73, s73, 14
    s_add_u32 s73, s73, s74
    s_lshr_b32 s74, s64, 2
    s_lshl_b32 s74, s74, 13
    s_add_u32 s73, s73, s74
    v_add_u32 v83, s73, v2
    s_xor_b32 s73, s66, 1
    s_and_b32 s74, s73, 1
    s_lshl_b32 s74, s74, 15
    s_lshr_b32 s73, s73, 1
    s_lshl_b32 s73, s73, 14
    s_add_u32 s73, s73, s74
    s_lshl_b32 s74, s64, 11
    s_add_u32 s5, s73, s74
    s_lshl_b32 s71, s65, 16
    s_add_u32 s71, s71, s5
    s_add_u32 s9, s71, 2097152
    s_xor_b32 s73, s66, 2
    s_and_b32 s74, s73, 1
    s_lshl_b32 s74, s74, 15
    s_lshr_b32 s73, s73, 1
    s_lshl_b32 s73, s73, 14
    s_add_u32 s73, s73, s74
    s_lshl_b32 s74, s64, 11
    s_add_u32 s6, s73, s74
    s_lshl_b32 s71, s65, 16
    s_add_u32 s71, s71, s6
    s_add_u32 s10, s71, 2097152
    s_xor_b32 s73, s66, 3
    s_and_b32 s74, s73, 1
    s_lshl_b32 s74, s74, 15
    s_lshr_b32 s73, s73, 1
    s_lshl_b32 s73, s73, 14
    s_add_u32 s73, s73, s74
    s_lshl_b32 s74, s64, 11
    s_add_u32 s7, s73, s74
    s_lshl_b32 s71, s65, 16
    s_add_u32 s71, s71, s7
    s_add_u32 s11, s71, 2097152
    ds_read_b128 v[48:51], v80 offset:0
    ds_read_b128 v[52:55], v80 offset:1024
    ds_read_b128 v[56:59], v80 offset:2048
    ds_read_b128 v[60:63], v80 offset:3072
    ds_read_b128 v[64:67], v80 offset:4096
    ds_read_b128 v[68:71], v80 offset:5120
    ds_read_b128 v[72:75], v80 offset:6144
    ds_read_b128 v[76:79], v80 offset:7168
    s_waitcnt lgkmcnt(7)
    v_mfma_f32_32x32x16_bf16 v[16:31], a[0:3], v[48:51], 0
    s_waitcnt lgkmcnt(6)
    v_mfma_f32_32x32x16_bf16 v[32:47], a[4:7], v[52:55], 0
    s_waitcnt lgkmcnt(5)
    v_mfma_f32_32x32x16_bf16 v[16:31], a[8:11], v[56:59], v[16:31]
    s_waitcnt lgkmcnt(4)
    v_mfma_f32_32x32x16_bf16 v[32:47], a[12:15], v[60:63], v[32:47]
    s_waitcnt lgkmcnt(3)
    v_mfma_f32_32x32x16_bf16 v[16:31], a[16:19], v[64:67], v[16:31]
    s_waitcnt lgkmcnt(2)
    v_mfma_f32_32x32x16_bf16 v[32:47], a[20:23], v[68:71], v[32:47]
    s_waitcnt lgkmcnt(1)
    v_mfma_f32_32x32x16_bf16 v[16:31], a[24:27], v[72:75], v[16:31]
    s_waitcnt lgkmcnt(0)
    v_mfma_f32_32x32x16_bf16 v[32:47], a[28:31], v[76:79], v[32:47]
    s_cmp_eq_u32 s64, 0
    s_cbranch_scc0 L_ofl_done
    v_and_b32 v5, 31, v1
    v_lshlrev_b32 v5, 2, v5
    s_mov_b32 s86, 262144
L_ofl:
    buffer_load_dword v6, v5, s[60:63], s75 offen sc1
    s_waitcnt vmcnt(0)
    v_cmp_ne_u32_e64 s[88:89], s70, v6
    s_nop 3
    s_cmp_eq_u64 s[88:89], 0
    s_cbranch_scc1 L_ofl_done
    s_sub_u32 s86, s86, 1
    s_cmp_lg_u32 s86, 0
    s_cbranch_scc1 L_ofl
    v_mov_b32 v4, 3
    v_mov_b32 v5, 60
    global_store_dword v5, v4, s[28:29]
L_ofl_done:
    s_barrier
    s_mov_b32 m0, s5
    s_nop 0
    buffer_load_dwordx4 v2, s[60:63], s9 offen lds
    buffer_load_dwordx4 v2, s[60:63], s9 offen offset:1024 lds
    s_mov_b32 m0, s6
    s_nop 0
    buffer_load_dwordx4 v2, s[60:63], s10 offen lds
    buffer_load_dwordx4 v2, s[60:63], s10 offen offset:1024 lds
    s_mov_b32 m0, s7
    s_nop 0
    buffer_load_dwordx4 v2, s[60:63], s11 offen lds
    buffer_load_dwordx4 v2, s[60:63], s11 offen offset:1024 lds
    s_waitcnt vmcnt(4)
    s_barrier
    ds_read_b128 v[48:51], v81 offset:0
    ds_read_b128 v[52:55], v81 offset:1024
    ds_read_b128 v[56:59], v81 offset:2048
    ds_read_b128 v[60:63], v81 offset:3072
    ds_read_b128 v[64:67], v81 offset:4096
    ds_read_b128 v[68:71], v81 offset:5120
    ds_read_b128 v[72:75], v81 offset:6144
    ds_read_b128 v[76:79], v81 offset:7168
    s_waitcnt lgkmcnt(7)
    v_mfma_f32_32x32x16_bf16 v[16:31], a[32:35], v[48:51], v[16:31]
    s_waitcnt lgkmcnt(6)
    v_mfma_f32_32x32x16_bf16 v[32:47], a[36:39], v[52:55], v[32:47]
    s_waitcnt lgkmcnt(5)
    v_mfma_f32_32x32x16_bf16 v[16:31], a[40:43], v[56:59], v[16:31]
    s_waitcnt lgkmcnt(4)
    v_mfma_f32_32x32x16_bf16 v[32:47], a[44:47], v[60:63], v[32:47]
    s_waitcnt lgkmcnt(3)
    v_mfma_f32_32x32x16_bf16 v[16:31], a[48:51], v[64:67], v[16:31]
    s_waitcnt lgkmcnt(2)
    v_mfma_f32_32x32x16_bf16 v[32:47], a[52:55], v[68:71], v[32:47]
    s_waitcnt lgkmcnt(1)
    v_mfma_f32_32x32x16_bf16 v[16:31], a[56:59], v[72:75], v[16:31]
    s_waitcnt lgkmcnt(0)
    v_mfma_f32_32x32x16_bf16 v[32:47], a[60:63], v[76:79], v[32:47]
    s_waitcnt vmcnt(2)
    s_barrier
    ds_read_b128 v[48:51], v82 offset:0
    ds_read_b128 v[52:55], v82 offset:1024
    ds_read_b128 v[56:59], v82 offset:2048
    ds_read_b128 v[60:63], v82 offset:3072
    ds_read_b128 v[64:67], v82 offset:4096
    ds_read_b128 v[68:71], v82 offset:5120
    ds_read_b128 v[72:75], v82 offset:6144
    ds_read_b128 v[76:79], v82 offset:7168
    s_waitcnt lgkmcnt(7)
    v_mfma_f32_32x32x16_bf16 v[16:31], a[64:67], v[48:51], v[16:31]
    s_waitcnt lgkmcnt(6)
    v_mfma_f32_32x32x16_bf16 v[32:47], a[68:71], v[52:55], v[32:47]
    s_waitcnt lgkmcnt(5)
    v_mfma_f32_32x32x16_bf16 v[16:31], a[72:75], v[56:59], v[16:31]
    s_waitcnt lgkmcnt(4)
    v_mfma_f32_32x32x16_bf16 v[32:47], a[76:79], v[60:63], v[32:47]
    s_waitcnt lgkmcnt(3)
    v_mfma_f32_32x32x16_bf16 v[16:31], a[80:83], v[64:67], v[16:31]
    s_waitcnt lgkmcnt(2)
    v_mfma_f32_32x32x16_bf16 v[32:47], a[84:87], v[68:71], v[32:47]
    s_waitcnt lgkmcnt(1)
    v_mfma_f32_32x32x16_bf16 v[16:31], a[88:91], v[72:75], v[16:31]
    s_waitcnt lgkmcnt(0)
    v_mfma_f32_32x32x16_bf16 v[32:47], a[92:95], v[76:79], v[32:47]
    s_waitcnt vmcnt(0)
    s_barrier
    ds_read_b128 v[48:51], v83 offset:0
    ds_read_b128 v[52:55], v83 offset:1024
    ds_read_b128 v[56:59], v83 offset:2048
    ds_read_b128 v[60:63], v83 offset:3072
    ds_read_b128 v[64:67], v83 offset:4096
    ds_read_b128 v[68:71], v83 offset:5120
    ds_read_b128 v[72:75], v83 offset:6144
    ds_read_b128 v[76:79], v83 offset:7168
    s_waitcnt lgkmcnt(7)
    v_mfma_f32_32x32x16_bf16 v[16:31], a[96:99], v[48:51], v[16:31]
    s_waitcnt lgkmcnt(6)
    v_mfma_f32_32x32x16_bf16 v[32:47], a[100:103], v[52:55], v[32:47]
    s_waitcnt lgkmcnt(5)
    v_mfma_f32_32x32x16_bf16 v[16:31], a[104:107], v[56:59], v[16:31]
    s_waitcnt lgkmcnt(4)
    v_mfma_f32_32x32x16_bf16 v[32:47], a[108:111], v[60:63], v[32:47]
    s_waitcnt lgkmcnt(3)
    v_mfma_f32_32x32x16_bf16 v[16:31], a[112:115], v[64:67], v[16:31]
    s_waitcnt lgkmcnt(2)
    v_mfma_f32_32x32x16_bf16 v[32:47], a[116:119], v[68:71], v[32:47]
    s_waitcnt lgkmcnt(1)
    v_mfma_f32_32x32x16_bf16 v[16:31], a[120:123], v[72:75], v[16:31]
    s_waitcnt lgkmcnt(0)
    v_mfma_f32_32x32x16_bf16 v[32:47], a[124:127], v[76:79], v[32:47]
    s_lshl_b32 s71, s64, 11
    s_add_u32 s71, s71, 65536
    s_xor_b32 s72, s64, 4
    s_lshl_b32 s72, s72, 11
    s_add_u32 s72, s72, 65536
    v_add_u32 v4, s71, v2
    v_add_u32 v7, s72, v2
    v_and_b32 v5, 31, v1
    v_lshlrev_b32 v5, 10, v5
    v_lshrrev_b32 v6, 5, v1
    v_lshlrev_b32 v6, 3, v6
    v_add_u32 v5, v5, v6
    s_lshl_b32 s71, s66, 8
    s_and_b32 s72, s64, 3
    s_lshl_b32 s72, s72, 6
    s_add_u32 s71, s71, s72
    s_add_u32 s71, s71, s85
    s_nop 7
    v_add_f32 v16, v16, v32
    v_add_f32 v17, v17, v33
    v_add_f32 v18, v18, v34
    v_add_f32 v19, v19, v35
    v_add_f32 v20, v20, v36
    v_add_f32 v21, v21, v37
    v_add_f32 v22, v22, v38
    v_add_f32 v23, v23, v39
    v_add_f32 v24, v24, v40
    v_add_f32 v25, v25, v41
    v_add_f32 v26, v26, v42
    v_add_f32 v27, v27, v43
    v_add_f32 v28, v28, v44
    v_add_f32 v29, v29, v45
    v_add_f32 v30, v30, v46
    v_add_f32 v31, v31, v47
    s_cmp_ge_u32 s64, 4
    s_cbranch_scc1 L_red_hi
    ds_write_b128 v4, v[24:27]
    ds_write_b128 v4, v[28:31] offset:1024
    s_waitcnt lgkmcnt(0)
    s_barrier
    ds_read_b128 v[48:51], v7
    ds_read_b128 v[52:55], v7 offset:1024
    s_waitcnt lgkmcnt(0)
    v_add_f32 v16, v16, v48
    v_add_f32 v17, v17, v49
    v_add_f32 v18, v18, v50
    v_add_f32 v19, v19, v51
    v_add_f32 v20, v20, v52
    v_add_f32 v21, v21, v53
    v_add_f32 v22, v22, v54
    v_add_f32 v23, v23, v55
    v_cvt_pk_bf16_f32 v64, v16, v17
    v_cvt_pk_bf16_f32 v65, v18, v19
    v_cvt_pk_bf16_f32 v66, v20, v21
    v_cvt_pk_bf16_f32 v67, v22, v23
    buffer_store_dwordx2 v[64:65], v5, s[56:59], s71 offen
    buffer_store_dwordx2 v[66:67], v5, s[56:59], s71 offen offset:16
    s_or_b32 s71, s2, s64
    s_cmp_eq_u32 s71, 0
    s_cbranch_scc0 L_fin
    v_mov_b32 v4, s70
    v_mov_b32 v5, 0
    s_mov_b32 s71, 278528
    s_mov_b64 exec, 1
    buffer_store_dword v4, v5, s[60:63], s71 offen sc1
    s_mov_b64 exec, -1
    s_branch L_fin
L_red_hi:
    ds_write_b128 v4, v[16:19]
    ds_write_b128 v4, v[20:23] offset:1024
    s_waitcnt lgkmcnt(0)
    s_barrier
    ds_read_b128 v[48:51], v7
    ds_read_b128 v[52:55], v7 offset:1024
    s_waitcnt lgkmcnt(0)
    v_add_f32 v24, v24, v48
    v_add_f32 v25, v25, v49
    v_add_f32 v26, v26, v50
    v_add_f32 v27, v27, v51
    v_add_f32 v28, v28, v52
    v_add_f32 v29, v29, v53
    v_add_f32 v30, v30, v54
    v_add_f32 v31, v31, v55
    v_cvt_pk_bf16_f32 v64, v24, v25
    v_cvt_pk_bf16_f32 v65, v26, v27
    v_cvt_pk_bf16_f32 v66, v28, v29
    v_cvt_pk_bf16_f32 v67, v30, v31
    buffer_store_dwordx2 v[64:65], v5, s[56:59], s71 offen offset:32
    buffer_store_dwordx2 v[66:67], v5, s[56:59], s71 offen offset:48
L_fin:
    s_waitcnt vmcnt(0)
L_end:
    s_endpgm
L_blk_1:
    v_bfe_u32 v4, v1, 3, 2
    v_xor_b32 v4, s66, v4
    v_and_b32 v5, 1, v4
    v_lshlrev_b32 v5, 7, v5
    v_lshrrev_b32 v4, 1, v4
    v_lshlrev_b32 v4, 6, v4
    v_and_b32 v6, 7, v1
    v_lshlrev_b32 v6, 2, v6
    v_add3_u32 v4, v4, v5, v6
    s_lshr_b32 s71, s64, 2
    s_lshl_b32 s71, s71, 5
    s_add_u32 s71, s71, s66
    s_lshl_b32 s71, s71, 2
    s_add_u32 s71, s71, 266240
    v_lshlrev_b32 v4, 2, v4
    buffer_load_dword v124, v4, s[60:63], s71 offen sc1
    s_branch L_main_go
L_blk_2:
    v_and_b32 v4, 31, v1
    v_lshlrev_b32 v4, 5, v4
    v_add_u32 v4, 136704, v4
    ds_read_b128 v[112:115], v4
    ds_read_b128 v[116:119], v4 offset:16
    s_mov_b32 s71, 0xbfb8aa3b
    s_xor_b32 s72, s71, 0x80000000
    s_cmp_eq_u32 s67, 0
    s_cselect_b32 s71, s71, s72
    s_waitcnt lgkmcnt(0)
    v_add_f32 v112, v112, v113
    v_add_f32 v114, v114, v115
    v_add_f32 v116, v116, v117
    v_add_f32 v118, v118, v119
    v_add_f32 v112, v112, v114
    v_add_f32 v116, v116, v118
    v_add_f32 v112, v112, v116
    v_mul_f32 v112, s71, v112
    v_exp_f32 v112, v112
    s_nop 0
    v_add_f32 v112, 1.0, v112
    v_rcp_f32 v3, v112
    s_waitcnt vmcnt(0)
    s_mov_b32 s87, 0
    s_mov_b32 s86, 262144
L_wochk_f:
    s_waitcnt vmcnt(0)
    v_cmp_ne_u32_e64 s[88:89], s70, v124
    s_nop 3
    s_cmp_eq_u64 s[88:89], 0
    s_cbranch_scc1 L_wook_f
    s_sleep 1
    v_bfe_u32 v4, v1, 3, 2
    v_xor_b32 v4, s66, v4
    v_and_b32 v5, 1, v4
    v_lshlrev_b32 v5, 7, v5
    v_lshrrev_b32 v4, 1, v4
    v_lshlrev_b32 v4, 6, v4
    v_and_b32 v6, 7, v1
    v_lshlrev_b32 v6, 2, v6
    v_add3_u32 v4, v4, v5, v6
    s_lshr_b32 s71, s64, 2
    s_lshl_b32 s71, s71, 5
    s_add_u32 s71, s71, s66
    s_lshl_b32 s71, s71, 2
    s_add_u32 s71, s71, 266240
    v_lshlrev_b32 v4, 2, v4
    buffer_load_dword v124, v4, s[60:63], s71 offen sc1
    s_sub_u32 s86, s86, 1
    s_cmp_lg_u32 s86, 0
    s_cbranch_scc1 L_wochk_f
    v_mov_b32 v4, 2
    v_mov_b32 v5, 60
    global_store_dword v5, v4, s[28:29]
L_wook_f:
    s_and_b32 s72, s64, 3
    s_lshl_b32 s73, s66, 2
    s_add_u32 s72, s72, s73
    s_lshl_b32 s72, s72, 10
    s_lshr_b32 s73, s64, 2
    s_lshl_b32 s73, s73, 17
    s_add_u32 s72, s72, s73
    s_add_u32 s72, s72, 524288
    s_xor_b32 s73, s66, 0
    s_and_b32 s74, s73, 1
    s_lshl_b32 s74, s74, 19
    s_lshr_b32 s73, s73, 1
    s_lshl_b32 s73, s73, 18
    s_add_u32 s71, s72, s73
    s_add_u32 s71, s71, s74
    buffer_load_dwordx4 a[0:3], v2, s[60:63], s71 offen
    s_add_u32 s71, s71, 16384
    buffer_load_dwordx4 a[4:7], v2, s[60:63], s71 offen
    s_add_u32 s71, s71, 16384
    buffer_load_dwordx4 a[8:11], v2, s[60:63], s71 offen
    s_add_u32 s71, s71, 16384
    buffer_load_dwordx4 a[12:15], v2, s[60:63], s71 offen
    s_add_u32 s71, s71, 16384
    buffer_load_dwordx4 a[16:19], v2, s[60:63], s71 offen
    s_add_u32 s71, s71, 16384
    buffer_load_dwordx4 a[20:23], v2, s[60:63], s71 offen
    s_add_u32 s71, s71, 16384
    buffer_load_dwordx4 a[24:27], v2, s[60:63], s71 offen
    s_add_u32 s71, s71, 16384
    buffer_load_dwordx4 a[28:31], v2, s[60:63], s71 offen
    s_xor_b32 s73, s66, 1
    s_and_b32 s74, s73, 1
    s_lshl_b32 s74, s74, 19
    s_lshr_b32 s73, s73, 1
    s_lshl_b32 s73, s73, 18
    s_add_u32 s71, s72, s73
    s_add_u32 s71, s71, s74
    buffer_load_dwordx4 a[32:35], v2, s[60:63], s71 offen
    s_add_u32 s71, s71, 16384
    buffer_load_dwordx4 a[36:39], v2, s[60:63], s71 offen
    s_add_u32 s71, s71, 16384
    buffer_load_dwordx4 a[40:43], v2, s[60:63], s71 offen
    s_add_u32 s71, s71, 16384
    buffer_load_dwordx4 a[44:47], v2, s[60:63], s71 offen
    s_add_u32 s71, s71, 16384
    buffer_load_dwordx4 a[48:51], v2, s[60:63], s71 offen
    s_add_u32 s71, s71, 16384
    buffer_load_dwordx4 a[52:55], v2, s[60:63], s71 offen
    s_add_u32 s71, s71, 16384
    buffer_load_dwordx4 a[56:59], v2, s[60:63], s71 offen
    s_add_u32 s71, s71, 16384
    buffer_load_dwordx4 a[60:63], v2, s[60:63], s71 offen
    s_xor_b32 s73, s66, 2
    s_and_b32 s74, s73, 1
    s_lshl_b32 s74, s74, 19
    s_lshr_b32 s73, s73, 1
    s_lshl_b32 s73, s73, 18
    s_add_u32 s71, s72, s73
    s_add_u32 s71, s71, s74
    buffer_load_dwordx4 a[64:67], v2, s[60:63], s71 offen
    s_add_u32 s71, s71, 16384
    buffer_load_dwordx4 a[68:71], v2, s[60:63], s71 offen
    s_add_u32 s71, s71, 16384
    buffer_load_dwordx4 a[72:75], v2, s[60:63], s71 offen
    s_add_u32 s71, s71, 16384
    buffer_load_dwordx4 a[76:79], v2, s[60:63], s71 offen
    s_add_u32 s71, s71, 16384
    buffer_load_dwordx4 a[80:83], v2, s[60:63], s71 offen
    s_add_u32 s71, s71, 16384
    buffer_load_dwordx4 a[84:87], v2, s[60:63], s71 offen
    s_add_u32 s71, s71, 16384
    buffer_load_dwordx4 a[88:91], v2, s[60:63], s71 offen
    s_add_u32 s71, s71, 16384
    buffer_load_dwordx4 a[92:95], v2, s[60:63], s71 offen
    s_xor_b32 s73, s66, 3
    s_and_b32 s74, s73, 1
    s_lshl_b32 s74, s74, 19
    s_lshr_b32 s73, s73, 1
    s_lshl_b32 s73, s73, 18
    s_add_u32 s71, s72, s73
    s_add_u32 s71, s71, s74
    buffer_load_dwordx4 a[96:99], v2, s[60:63], s71 offen
    s_add_u32 s71, s71, 16384
    buffer_load_dwordx4 a[100:103], v2, s[60:63], s71 offen
    s_add_u32 s71, s71, 16384
    buffer_load_dwordx4 a[104:107], v2, s[60:63], s71 offen
    s_add_u32 s71, s71, 16384
    buffer_load_dwordx4 a[108:111], v2, s[60:63], s71 offen
    s_add_u32 s71, s71, 16384
    buffer_load_dwordx4 a[112:115], v2, s[60:63], s71 offen
    s_add_u32 s71, s71, 16384
    buffer_load_dwordx4 a[116:119], v2, s[60:63], s71 offen
    s_add_u32 s71, s71, 16384
    buffer_load_dwordx4 a[120:123], v2, s[60:63], s71 offen
    s_add_u32 s71, s71, 16384
    buffer_load_dwordx4 a[124:127], v2, s[60:63], s71 offen
    s_branch L_main_go
L_blk_bar:
    s_waitcnt vmcnt(0)
    s_barrier
    s_cmp_eq_u32 s64, 3
    s_cbranch_scc0 L_wf28
    s_lshl_b32 s71, s2, 2
    s_add_u32 s71, s71, 266240
    v_mov_b32 v4, s70
    v_mov_b32 v5, 0
    s_mov_b64 exec, 1
    buffer_store_dword v4, v5, s[60:63], s71 offen sc1
    s_mov_b64 exec, -1
L_wf28:
    s_branch L_main_t6
L_blk_prio:
    s_setprio 0
    s_branch L_main_tp
L_slow:
    v_mov_b32 v108, 0xff800000
    v_mov_b32 v109, 0xff800000
    s_mov_b32 s84, 0
L_slow_loop:
    s_cmp_eq_u32 s84, 6
    s_cbranch_scc0 L_slow_nb
    s_waitcnt vmcnt(0)
    s_barrier
    s_cmp_eq_u32 s64, 3
    s_cbranch_scc0 L_wf29
    s_lshl_b32 s71, s2, 2
    s_add_u32 s71, s71, 266240
    v_mov_b32 v4, s70
    v_mov_b32 v5, 0
    s_mov_b64 exec, 1
    buffer_store_dword v4, v5, s[60:63], s71 offen sc1
    s_mov_b64 exec, -1
L_wf29:
L_slow_nb:
    ds_read_b128 v[80:83], v101
    s_mov_b64 exec, s[80:81]
    ds_read_b128 v[84:87], v102 offset:1024
    ds_read_b128 v[88:91], v102 offset:1536
    s_mov_b64 exec, -1
    s_waitcnt lgkmcnt(0)
    v_mfma_f32_32x32x16_bf16 v[48:63], v[80:83], v[8:11], 0
    s_nop 15
    v_max3_f32 v4, v48, v49, v50
    v_max3_f32 v4, v4, v51, v52
    v_max3_f32 v4, v4, v53, v54
    v_max3_f32 v4, v4, v55, v56
    v_max3_f32 v4, v4, v57, v58
    v_max3_f32 v4, v4, v59, v60
    v_max3_f32 v4, v4, v61, v62
    v_max_f32 v4, v4, v63
    s_nop 0
    v_mov_b32 v5, v4
    s_nop 1
    v_permlane32_swap_b32 v4, v5
    s_nop 1
    v_max3_f32 v4, v4, v5, v108
    v_sub_f32 v5, v108, v4
    v_exp_f32 v5, v5
    v_mov_b32 v108, v4
    v_mul_f32 v16, v5, v16
    v_mul_f32 v17, v5, v17
    v_mul_f32 v18, v5, v18
    v_mul_f32 v19, v5, v19
    v_mul_f32 v20, v5, v20
    v_mul_f32 v21, v5, v21
    v_mul_f32 v22, v5, v22
    v_mul_f32 v23, v5, v23
    v_mul_f32 v24, v5, v24
    v_sub_f32 v48, v48, v4
    v_sub_f32 v49, v49, v4
    v_sub_f32 v50, v50, v4
    v_sub_f32 v51, v51, v4
    v_sub_f32 v52, v52, v4
    v_sub_f32 v53, v53, v4
    v_sub_f32 v54, v54, v4
    v_sub_f32 v55, v55, v4
    v_sub_f32 v56, v56, v4
    v_sub_f32 v57, v57, v4
    v_sub_f32 v58, v58, v4
    v_sub_f32 v59, v59, v4
    v_sub_f32 v60, v60, v4
    v_sub_f32 v61, v61, v4
    v_sub_f32 v62, v62, v4
    v_sub_f32 v63, v63, v4
    v_exp_f32 v48, v48
    v_exp_f32 v49, v49
    v_exp_f32 v50, v50
    v_exp_f32 v51, v51
    v_exp_f32 v52, v52
    v_exp_f32 v53, v53
    v_exp_f32 v54, v54
    v_exp_f32 v55, v55
    v_exp_f32 v56, v56
    v_exp_f32 v57, v57
    v_exp_f32 v58, v58
    v_exp_f32 v59, v59
    v_exp_f32 v60, v60
    v_exp_f32 v61, v61
    v_exp_f32 v62, v62
    v_exp_f32 v63, v63
    s_nop 1
    v_smfmac_f32_32x32x32_bf16 v[16:31], v[84:87], v[48:55], v100
    v_smfmac_f32_32x32x32_bf16 v[16:31], v[88:91], v[56:63], v100
    v_mfma_f32_32x32x16_bf16 v[48:63], v[80:83], v[12:15], 0
    s_nop 15
    v_max3_f32 v4, v48, v49, v50
    v_max3_f32 v4, v4, v51, v52
    v_max3_f32 v4, v4, v53, v54
    v_max3_f32 v4, v4, v55, v56
    v_max3_f32 v4, v4, v57, v58
    v_max3_f32 v4, v4, v59, v60
    v_max3_f32 v4, v4, v61, v62
    v_max_f32 v4, v4, v63
    s_nop 0
    v_mov_b32 v5, v4
    s_nop 1
    v_permlane32_swap_b32 v4, v5
    s_nop 1
    v_max3_f32 v4, v4, v5, v109
    v_sub_f32 v5, v109, v4
    v_exp_f32 v5, v5
    v_mov_b32 v109, v4
    v_mul_f32 v32, v5, v32
    v_mul_f32 v33, v5, v33
    v_mul_f32 v34, v5, v34
    v_mul_f32 v35, v5, v35
    v_mul_f32 v36, v5, v36
    v_mul_f32 v37, v5, v37
    v_mul_f32 v38, v5, v38
    v_mul_f32 v39, v5, v39
    v_mul_f32 v40, v5, v40
    v_sub_f32 v48, v48, v4
    v_sub_f32 v49, v49, v4
    v_sub_f32 v50, v50, v4
    v_sub_f32 v51, v51, v4
    v_sub_f32 v52, v52, v4
    v_sub_f32 v53, v53, v4
    v_sub_f32 v54, v54, v4
    v_sub_f32 v55, v55, v4
    v_sub_f32 v56, v56, v4
    v_sub_f32 v57, v57, v4
    v_sub_f32 v58, v58, v4
    v_sub_f32 v59, v59, v4
    v_sub_f32 v60, v60, v4
    v_sub_f32 v61, v61, v4
    v_sub_f32 v62, v62, v4
    v_sub_f32 v63, v63, v4
    v_exp_f32 v48, v48
    v_exp_f32 v49, v49
    v_exp_f32 v50, v50
    v_exp_f32 v51, v51
    v_exp_f32 v52, v52
    v_exp_f32 v53, v53
    v_exp_f32 v54, v54
    v_exp_f32 v55, v55
    v_exp_f32 v56, v56
    v_exp_f32 v57, v57
    v_exp_f32 v58, v58
    v_exp_f32 v59, v59
    v_exp_f32 v60, v60
    v_exp_f32 v61, v61
    v_exp_f32 v62, v62
    v_exp_f32 v63, v63
    s_nop 1
    v_smfmac_f32_32x32x32_bf16 v[32:47], v[84:87], v[48:55], v100
    v_smfmac_f32_32x32x32_bf16 v[32:47], v[88:91], v[56:63], v100
    v_add_u32 v101, 2048, v101
    v_add_u32 v102, 2048, v102
    s_add_u32 s84, s84, 1
    s_cmp_lt_u32 s84, 64
    s_cbranch_scc1 L_slow_loop
    v_and_b32 v4, 31, v1
    v_lshlrev_b32 v4, 5, v4
    v_add_u32 v4, 136704, v4
    ds_read_b128 v[112:115], v4
    ds_read_b128 v[116:119], v4 offset:16
    s_mov_b32 s71, 0xbfb8aa3b
    s_xor_b32 s72, s71, 0x80000000
    s_cmp_eq_u32 s67, 0
    s_cselect_b32 s71, s71, s72
    s_waitcnt lgkmcnt(0)
    v_add_f32 v112, v112, v113
    v_add_f32 v114, v114, v115
    v_add_f32 v116, v116, v117
    v_add_f32 v118, v118, v119
    v_add_f32 v112, v112, v114
    v_add_f32 v116, v116, v118
    v_add_f32 v112, v112, v116
    v_mul_f32 v112, s71, v112
    v_exp_f32 v112, v112
    s_nop 0
    v_add_f32 v112, 1.0, v112
    v_rcp_f32 v3, v112
    s_mov_b32 s87, 0
    v_bfe_u32 v4, v1, 3, 2
    v_xor_b32 v4, s66, v4
    v_and_b32 v5, 1, v4
    v_lshlrev_b32 v5, 7, v5
    v_lshrrev_b32 v4, 1, v4
    v_lshlrev_b32 v4, 6, v4
    v_and_b32 v6, 7, v1
    v_lshlrev_b32 v6, 2, v6
    v_add3_u32 v4, v4, v5, v6
    s_lshr_b32 s71, s64, 2
    s_lshl_b32 s71, s71, 5
    s_add_u32 s71, s71, s66
    s_lshl_b32 s71, s71, 2
    s_add_u32 s71, s71, 266240
    v_lshlrev_b32 v4, 2, v4
    buffer_load_dword v124, v4, s[60:63], s71 offen sc1
    s_mov_b32 s86, 262144
L_wochk_s:
    s_waitcnt vmcnt(0)
    v_cmp_ne_u32_e64 s[88:89], s70, v124
    s_nop 3
    s_cmp_eq_u64 s[88:89], 0
    s_cbranch_scc1 L_wook_s
    s_sleep 1
    v_bfe_u32 v4, v1, 3, 2
    v_xor_b32 v4, s66, v4
    v_and_b32 v5, 1, v4
    v_lshlrev_b32 v5, 7, v5
    v_lshrrev_b32 v4, 1, v4
    v_lshlrev_b32 v4, 6, v4
    v_and_b32 v6, 7, v1
    v_lshlrev_b32 v6, 2, v6
    v_add3_u32 v4, v4, v5, v6
    s_lshr_b32 s71, s64, 2
    s_lshl_b32 s71, s71, 5
    s_add_u32 s71, s71, s66
    s_lshl_b32 s71, s71, 2
    s_add_u32 s71, s71, 266240
    v_lshlrev_b32 v4, 2, v4
    buffer_load_dword v124, v4, s[60:63], s71 offen sc1
    s_sub_u32 s86, s86, 1
    s_cmp_lg_u32 s86, 0
    s_cbranch_scc1 L_wochk_s
    v_mov_b32 v4, 2
    v_mov_b32 v5, 60
    global_store_dword v5, v4, s[28:29]
L_wook_s:
    s_and_b32 s72, s64, 3
    s_lshl_b32 s73, s66, 2
    s_add_u32 s72, s72, s73
    s_lshl_b32 s72, s72, 10
    s_lshr_b32 s73, s64, 2
    s_lshl_b32 s73, s73, 17
    s_add_u32 s72, s72, s73
    s_add_u32 s72, s72, 524288
    s_xor_b32 s73, s66, 0
    s_and_b32 s74, s73, 1
    s_lshl_b32 s74, s74, 19
    s_lshr_b32 s73, s73, 1
    s_lshl_b32 s73, s73, 18
    s_add_u32 s71, s72, s73
    s_add_u32 s71, s71, s74
    buffer_load_dwordx4 a[0:3], v2, s[60:63], s71 offen
    s_add_u32 s71, s71, 16384
    buffer_load_dwordx4 a[4:7], v2, s[60:63], s71 offen
    s_add_u32 s71, s71, 16384
    buffer_load_dwordx4 a[8:11], v2, s[60:63], s71 offen
    s_add_u32 s71, s71, 16384
    buffer_load_dwordx4 a[12:15], v2, s[60:63], s71 offen
    s_add_u32 s71, s71, 16384
    buffer_load_dwordx4 a[16:19], v2, s[60:63], s71 offen
    s_add_u32 s71, s71, 16384
    buffer_load_dwordx4 a[20:23], v2, s[60:63], s71 offen
    s_add_u32 s71, s71, 16384
    buffer_load_dwordx4 a[24:27], v2, s[60:63], s71 offen
    s_add_u32 s71, s71, 16384
    buffer_load_dwordx4 a[28:31], v2, s[60:63], s71 offen
    s_xor_b32 s73, s66, 1
    s_and_b32 s74, s73, 1
    s_lshl_b32 s74, s74, 19
    s_lshr_b32 s73, s73, 1
    s_lshl_b32 s73, s73, 18
    s_add_u32 s71, s72, s73
    s_add_u32 s71, s71, s74
    buffer_load_dwordx4 a[32:35], v2, s[60:63], s71 offen
    s_add_u32 s71, s71, 16384
    buffer_load_dwordx4 a[36:39], v2, s[60:63], s71 offen
    s_add_u32 s71, s71, 16384
    buffer_load_dwordx4 a[40:43], v2, s[60:63], s71 offen
    s_add_u32 s71, s71, 16384
    buffer_load_dwordx4 a[44:47], v2, s[60:63], s71 offen
    s_add_u32 s71, s71, 16384
    buffer_load_dwordx4 a[48:51], v2, s[60:63], s71 offen
    s_add_u32 s71, s71, 16384
    buffer_load_dwordx4 a[52:55], v2, s[60:63], s71 offen
    s_add_u32 s71, s71, 16384
    buffer_load_dwordx4 a[56:59], v2, s[60:63], s71 offen
    s_add_u32 s71, s71, 16384
    buffer_load_dwordx4 a[60:63], v2, s[60:63], s71 offen
    s_xor_b32 s73, s66, 2
    s_and_b32 s74, s73, 1
    s_lshl_b32 s74, s74, 19
    s_lshr_b32 s73, s73, 1
    s_lshl_b32 s73, s73, 18
    s_add_u32 s71, s72, s73
    s_add_u32 s71, s71, s74
    buffer_load_dwordx4 a[64:67], v2, s[60:63], s71 offen
    s_add_u32 s71, s71, 16384
    buffer_load_dwordx4 a[68:71], v2, s[60:63], s71 offen
    s_add_u32 s71, s71, 16384
    buffer_load_dwordx4 a[72:75], v2, s[60:63], s71 offen
    s_add_u32 s71, s71, 16384
    buffer_load_dwordx4 a[76:79], v2, s[60:63], s71 offen
    s_add_u32 s71, s71, 16384
    buffer_load_dwordx4 a[80:83], v2, s[60:63], s71 offen
    s_add_u32 s71, s71, 16384
    buffer_load_dwordx4 a[84:87], v2, s[60:63], s71 offen
    s_add_u32 s71, s71, 16384
    buffer_load_dwordx4 a[88:91], v2, s[60:63], s71 offen
    s_add_u32 s71, s71, 16384
    buffer_load_dwordx4 a[92:95], v2, s[60:63], s71 offen
    s_xor_b32 s73, s66, 3
    s_and_b32 s74, s73, 1
    s_lshl_b32 s74, s74, 19
    s_lshr_b32 s73, s73, 1
    s_lshl_b32 s73, s73, 18
    s_add_u32 s71, s72, s73
    s_add_u32 s71, s71, s74
    buffer_load_dwordx4 a[96:99], v2, s[60:63], s71 offen
    s_add_u32 s71, s71, 16384
    buffer_load_dwordx4 a[100:103], v2, s[60:63], s71 offen
    s_add_u32 s71, s71, 16384
    buffer_load_dwordx4 a[104:107], v2, s[60:63], s71 offen
    s_add_u32 s71, s71, 16384
    buffer_load_dwordx4 a[108:111], v2, s[60:63], s71 offen
    s_add_u32 s71, s71, 16384
    buffer_load_dwordx4 a[112:115], v2, s[60:63], s71 offen
    s_add_u32 s71, s71, 16384
    buffer_load_dwordx4 a[116:119], v2, s[60:63], s71 offen
    s_add_u32 s71, s71, 16384
    buffer_load_dwordx4 a[120:123], v2, s[60:63], s71 offen
    s_add_u32 s71, s71, 16384
    buffer_load_dwordx4 a[124:127], v2, s[60:63], s71 offen
    s_branch L_epi
.section .rodata,"a"
.p2align 6
.amdhsa_kernel gated_mix__grouped_kv_mqa__grouped_kv_mqa__prompt_kernel
  .amdhsa_next_free_vgpr 256
  .amdhsa_next_free_sgpr 102
  .amdhsa_accum_offset 128
  .amdhsa_group_segment_fixed_size 0
  .amdhsa_kernarg_size 112
  .amdhsa_user_sgpr_count 2
  .amdhsa_user_sgpr_kernarg_segment_ptr 1
  .amdhsa_system_sgpr_workgroup_id_x 1
.end_amdhsa_kernel
```
